```python
import torch

def _softmax(x, axis=-1):
    return torch.softmax(x, dim=axis)
def _gelu(x):
    return torch.nn.functional.gelu(x, approximate="tanh")
def _silu(x):
    return torch.nn.functional.silu(x)
def _sigmoid(x):
    return torch.sigmoid(x)
def _layernorm(x, axis=-1, eps=1e-5):
    m = x.mean(dim=axis, keepdim=True)
    v = x.var(dim=axis, keepdim=True, unbiased=False)
    return (x - m) / torch.sqrt(v + eps)
def _scatter_add(tgt, idx, src, axis=0):
    return tgt.clone().index_add_(axis, idx, src)
def _segment_sum(src, seg, n):
    out = torch.zeros((n,) + src.shape[1:], dtype=src.dtype)
    return out.index_add_(0, seg, src)
def _pad(x, pw):
    flat = tuple(v for pair in reversed(pw) for v in pair)
    return torch.nn.functional.pad(x, flat)

kernel_name = 'standalone__cheap_equivariant_egnn__graph'

def setup_inputs():

    _w = (lambda a: (lambda t: t.to(torch.bfloat16) if t.is_floating_point() else t)(torch.as_tensor(a)))
    N, deg, D, De = 12500, 32, 128, max(0, 1)
    E = N * deg
    return {
        "h": _w((lambda *s: torch.randn(*s, dtype=torch.bfloat16) * 0.1)(N, D)),
        "pos": _w((lambda *s: torch.randn(*s, dtype=torch.bfloat16) * 0.8)(N, 3)),
        "e_attr": _w((lambda *s: torch.randn(*s, dtype=torch.bfloat16) * 0.8)(E, De)),
        "src": _w((lambda lo, hi, *s: torch.randint(lo, hi, s))(0, N, E).to(torch.int64)),
        "dst": _w((lambda lo, hi, *s: torch.randint(lo, hi, s))(0, N, E).to(torch.int64)),
        "w_e": _w(0.1 * (lambda *s: torch.randn(*s, dtype=torch.bfloat16) * 0.8)(2 * D + 1 + De, D)),
        "w_x": _w(0.1 * (lambda *s: torch.randn(*s, dtype=torch.bfloat16) * 0.1)(D, 1)),
        "w_h": _w(0.1 * (lambda *s: torch.randn(*s, dtype=torch.bfloat16) * 0.1)(2 * D, D)),
    }

def reference(h, pos, e_attr, src, dst, w_e, w_x, w_h):
    N, D = h.shape[0], h.shape[1]
    diff = pos[dst] - pos[src]
    dist2 = torch.sum(diff * diff, axis=-1, keepdims=True)
    e_in = torch.concatenate([h[dst], h[src], dist2, e_attr], axis=-1)
    m_ij = _silu(e_in @ w_e)
    coord_scale = m_ij @ w_x
    pos_new = pos + _segment_sum(diff * coord_scale, dst, N)
    m_i = _segment_sum(m_ij, dst, N)
    h_new = h + _silu(torch.concatenate([h, m_i], axis=-1) @ w_h)
    return h_new, pos_new
```

```asm
; @launch grid=(256,1,1) block=(1024,1,1) lds=163840
.amdgcn_target "amdgcn-amd-amdhsa--gfx950"
.text
.globl standalone__cheap_equivariant_egnn__graph_kernel
.p2align 8
.type standalone__cheap_equivariant_egnn__graph_kernel,@function
standalone__cheap_equivariant_egnn__graph_kernel:
    s_load_dwordx16 s[4:19], s[0:1], 0
    s_load_dwordx4 s[20:23], s[0:1], 64
    s_load_dwordx2 s[24:25], s[0:1], 80
    v_lshrrev_b32 v1, 6, v0
    s_cmp_ge_u32 s2, 256
    s_cbranch_scc1 K_END
    v_readfirstlane_b32 s3, v1
    v_mov_b32 v18, v0
    v_lshlrev_b32 v19, 4, v0
    v_and_b32 v0, 63, v0
    s_and_b32 s44, s2, 7
    s_lshl_b32 s44, s44, 5
    s_lshr_b32 s79, s2, 3
    s_add_u32 s44, s44, s79
    s_mul_i32 s45, s44, 49
    s_lshl_b32 s76, s3, 8
    s_or_b32 s76, s76, s2
    s_cmp_eq_u32 s76, 3199
    s_cbranch_scc1 K_ZF
    s_cmp_ge_u32 s2, 125
    s_cbranch_scc1 K_LD
    s_mul_i32 s76, s2, 12800
    v_add_u32 v2, s76, v19
    v_lshrrev_b32 v3, 1, v2
    v_cmp_gt_u32 vcc, 800, v18
    s_cmp_eq_u32 s3, 8
    s_mov_b32 s78, 196608
    s_cmov_b32 s78, 21104
    s_cmp_lt_u32 s3, 8
    s_cselect_b32 s76, 0xbfbfbfbf, 0
    s_cselect_b32 s77, 64, 0
    s_cmov_b32 s78, 106752
    v_and_b32 v14, 0x3fe, v18
    v_mul_u32_u24 v14, s77, v14
    v_add3_u32 v14, v14, v19, s78
    v_mov_b32 v20, s76
    v_mov_b32 v21, s76
    v_mov_b32 v22, s76
    v_mov_b32 v23, s76
    s_mov_b64 s[88:89], vcc
    s_mov_b64 exec, vcc
    s_waitcnt lgkmcnt(0)
    s_cbranch_execz K_PL
    global_load_dwordx4 v[4:7], v2, s[12:13]
    global_load_dwordx4 v[8:11], v2, s[10:11]
    global_load_dwordx2 v[12:13], v3, s[8:9]
K_PL:
    s_mov_b64 exec, -1
    ds_write_b128 v14, v[20:23]
    s_waitcnt lgkmcnt(0)
    s_barrier
K_LD:
    s_sub_u32 s46, 12500, s45
    s_min_u32 s46, s46, 49
    s_lshl_b32 s78, s45, 8
    s_lshl_b32 s30, s46, 8
    s_mov_b32 s31, 0x20000
    v_lshrrev_b32 v14, 4, v0
    v_and_b32 v15, 15, v0
    s_lshr_b32 s52, s2, 7
    s_add_u32 s76, s3, s52
    s_waitcnt lgkmcnt(0)
    s_add_u32 s28, s4, s78
    s_addc_u32 s29, s5, 0
    s_cmp_lt_u32 s76, 13
    s_cbranch_scc1 K_CH
    s_cmp_eq_u32 s76, 14
    s_cselect_b32 s78, 200704, 0
    s_cselect_b32 s34, 12544, s30
    s_mov_b32 s82, 147712
    s_cmov_b32 s82, 32768
    s_sub_u32 s32, s28, s78
    s_subb_u32 s33, s29, 0
    s_and_b32 s76, s3, 1
    s_lshl_b32 s76, s76, 14
    s_add_u32 s77, s76, 73984
    s_lshl_b32 s78, s52, 15
    s_add_u32 s76, s76, s78
    s_and_b32 s79, s79, 3
    s_lshl_b32 s79, s79, 12
    s_cmp_lt_u32 s3, 14
    s_cselect_b64 s[32:33], s[32:33], s[14:15]
    s_cselect_b32 s34, s34, 0x10000
    s_mov_b32 s35, 0x20000
    s_cselect_b32 s80, 0, 1
    s_cselect_b32 s81, 64, 0
    s_cmov_b32 s76, 0
    s_cmov_b32 s77, s82
    s_cmov_b32 s79, 0
    v_lshlrev_b32 v20, s80, v14
    v_xor_b32 v20, v20, v15
    v_lshlrev_b32 v20, 4, v20
    v_lshl_add_u32 v20, v14, 8, v20
    v_xor_b32 v21, s81, v20
    v_xor_b32 v22, 0x80, v20
    v_xor_b32 v23, 0x80, v21
    s_cbranch_scc1 K_WP
    s_bfe_u32 s78, s2, 0x40003
    s_lshl_b32 s78, s78, 10
    s_add_u32 s78, s78, s76
    v_lshlrev_b32 v24, 4, v0
    buffer_load_dword v24, v24, s[32:35], s78 offen
    s_waitcnt vmcnt(0)
K_WP:
    s_add_u32 m0, s77, s79
    s_add_u32 s78, s76, s79
    buffer_load_dwordx4 v20, s[32:35], s78 offen offset:0 lds
    s_add_u32 s79, s79, 4096
    s_and_b32 s79, s79, 0x3fff
    buffer_load_dwordx4 v21, s[32:35], s78 offen offset:1024 lds
    buffer_load_dwordx4 v22, s[32:35], s78 offen offset:2048 lds
    buffer_load_dwordx4 v23, s[32:35], s78 offen offset:3072 lds
    s_add_u32 m0, s77, s79
    s_add_u32 s78, s76, s79
    buffer_load_dwordx4 v20, s[32:35], s78 offen offset:0 lds
    s_add_u32 s79, s79, 4096
    s_and_b32 s79, s79, 0x3fff
    buffer_load_dwordx4 v21, s[32:35], s78 offen offset:1024 lds
    buffer_load_dwordx4 v22, s[32:35], s78 offen offset:2048 lds
    buffer_load_dwordx4 v23, s[32:35], s78 offen offset:3072 lds
    s_add_u32 m0, s77, s79
    s_add_u32 s78, s76, s79
    buffer_load_dwordx4 v20, s[32:35], s78 offen offset:0 lds
    s_add_u32 s79, s79, 4096
    s_and_b32 s79, s79, 0x3fff
    buffer_load_dwordx4 v21, s[32:35], s78 offen offset:1024 lds
    buffer_load_dwordx4 v22, s[32:35], s78 offen offset:2048 lds
    buffer_load_dwordx4 v23, s[32:35], s78 offen offset:3072 lds
    s_add_u32 m0, s77, s79
    s_add_u32 s78, s76, s79
    s_cmp_lt_u32 s3, 14
    buffer_load_dwordx4 v20, s[32:35], s78 offen offset:0 lds
    s_cbranch_scc1 K_WJ
    buffer_load_dwordx4 v21, s[32:35], s78 offen offset:1024 lds
    buffer_load_dwordx4 v22, s[32:35], s78 offen offset:2048 lds
    buffer_load_dwordx4 v23, s[32:35], s78 offen offset:3072 lds
    s_cmp_lt_u32 s2, 128
    s_cbranch_scc1 K_LE
    s_lshl_b32 s76, s45, 8
    s_mul_i32 s78, s3, 6144
    s_add_u32 s76, s76, s78
    s_sub_u32 s76, s76, 83968
    v_and_b32 v24, 60, v0
    v_lshlrev_b32 v24, 4, v24
    v_lshl_add_u32 v24, v0, 4, v24
    v_add_u32 v24, s76, v24
    global_store_dwordx4 v24, v[20:23], s[24:25] offset:-2048 sc1
K_LE:
K_CH:
    s_setreg_imm32_b32 hwreg(HW_REG_MODE, 4, 2), 3
    s_mov_b32 s26, 3301376
    s_mov_b32 s27, 0x20000
    s_cmp_lt_u32 s2, 128
    s_cbranch_scc1 K_PFB
    s_cmp_eq_u32 s3, 0
    s_cbranch_scc1 K_PF
K_PFB:
    v_mov_b32 v24, 0
    v_mov_b32 v25, 0
    v_mov_b32 v26, 0
    v_mov_b32 v27, 0
    v_cmp_gt_u32 vcc, 279, v18
    ds_write_b128 v19, v[24:27] offset:8448
    v_lshlrev_b32 v28, 2, v0
    ds_write_b32 v28, v24 offset:0
    s_mov_b64 exec, vcc
    ds_write_b128 v19, v[24:27] offset:24832
    s_mov_b64 exec, -1
    s_lshr_b32 s79, s3, 3
    s_and_b32 s78, s3, 7
    s_sub_u32 s76, s79, 1
    v_and_b32 v17, s76, v15
    s_lshl_b32 s76, s79, 4
    s_add_u32 s76, s76, 16
    v_add_u32 v24, s76, v15
    s_mul_i32 s76, s79, 48
    v_add_u32 v25, s76, v17
    s_mov_b32 s76, 147712
    v_xor_b32 v26, v14, v15
    v_xor_b32 v27, v14, v17
    v_lshl_add_u32 v26, v26, 4, s76
    v_lshl_add_u32 v27, v27, 4, s76
    v_lshl_add_u32 v56, v24, 8, v26
    v_lshl_add_u32 v57, v25, 8, v27
    s_cmp_ge_u32 s2, 128
    s_cselect_b32 s76, 114944, 0
    v_subrev_u32 v84, s76, v56
    v_subrev_u32 v100, s76, v57
    v_xor_b32 v88, 64, v84
    v_xor_b32 v104, 64, v100
    v_xor_b32 v92, 128, v84
    v_xor_b32 v108, 128, v100
    v_xor_b32 v96, 192, v84
    v_xor_b32 v112, 192, v100
    s_lshl_b32 s76, s78, 5
    s_add_u32 s76, s76, 149728
    v_lshl_add_u32 v26, v14, 3, s76
    s_movk_i32 s76, 288
    v_mad_u32_u24 v118, v24, s76, v26
    v_mad_u32_u24 v119, v25, s76, v26
    v_bfe_u32 v28, v0, 2, 2
    v_and_b32 v27, 1, v14
    v_lshl_or_b32 v27, v27, 2, v28
    v_xor_b32 v27, s78, v27
    v_and_b32 v26, 3, v0
    v_lshlrev_b32 v26, 3, v26
    v_lshl_or_b32 v27, v27, 5, v26
    v_lshl_add_u32 v28, v14, 3, v28
    v_lshl_add_u32 v28, v28, 8, v27
    v_add_u32 v16, 73984, v28
    v_mov_b32 v58, 0
    s_sub_u32 s76, s3, 14
    v_mov_b32 v59, s76
    s_bitcmp1_b32 s3, 0
    s_mov_b32 s80, 0xbfb8aa3b
    s_cmov_b32 s80, 0x8d38aa3b
    s_lshl_b32 s76, s45, 8
    s_mul_i32 s77, s44, 8320
    s_add_u32 s77, s77, 4194304
    s_cmp_eq_u32 s44, 255
    s_cmov_b32 s77, 6340864
    s_cselect_b32 s36, 16, s3
    s_cmp_ge_u32 s36, 12
    s_cselect_b64 s[36:37], s[24:25], s[20:21]
    s_cmov_b32 s76, s77
    s_add_u32 s36, s36, s76
    s_addc_u32 s37, s37, 0
    s_cmp_ge_u32 s2, 125
    s_cbranch_scc1 K_NP
    s_add_u32 s86, s24, 4194304
    s_addc_u32 s87, s25, 0
    s_lshl_b32 s76, s2, 3
    v_lshrrev_b32 v24, 3, v18
    v_add_u32 v46, s76, v18
    v_and_b32 v46, 1023, v46
    v_mov_b32 v47, 0
    v_cmp_gt_u32 vcc, 768, v46
    v_mov_b32 v25, 8320
    v_lshl_add_u64 v[28:29], v[46:47], 4, s[86:87]
    s_mov_b64 exec, vcc
    v_mov_b32 v25, 12544
    v_lshl_add_u64 v[28:29], v[46:47], 4, s[20:21]
    s_mov_b64 exec, -1
    s_movk_i32 s76, 128
    s_mov_b32 s82, 106752
    v_mad_u64_u32 v[52:53], vcc, v24, v25, v[28:29]
    v_lshl_add_u32 v48, v24, 5, v19
    v_add_u32 v48, s82, v48
    v_mad_u64_u32 v[54:55], vcc, v25, s76, v[52:53]
    v_lshlrev_b32 v50, 2, v24
    s_cmp_ge_u32 s3, 13
    s_cbranch_scc1 K_PLD
    s_mov_b32 s76, 342393
    s_movk_i32 s77, 12544
    s_mov_b32 s83, 0xffff0000
    v_mov_b32 v44, 1
    s_mov_b64 exec, s[88:89]
    s_waitcnt vmcnt(2)
    v_mul_u32_u24 v4, s76, v4
    v_lshlrev_b32_sdwa v34, 2, v4 dst_sel:DWORD dst_unused:UNUSED_PAD src0_sel:DWORD src1_sel:BYTE_3
    ds_add_rtn_u32 v38, v34, v44 offset:29296
    v_mul_u32_u24 v5, s76, v5
    v_lshlrev_b32_sdwa v35, 2, v5 dst_sel:DWORD dst_unused:UNUSED_PAD src0_sel:DWORD src1_sel:BYTE_3
    ds_add_rtn_u32 v39, v35, v44 offset:29296
    v_mul_u32_u24 v6, s76, v6
    v_lshlrev_b32_sdwa v36, 2, v6 dst_sel:DWORD dst_unused:UNUSED_PAD src0_sel:DWORD src1_sel:BYTE_3
    ds_add_rtn_u32 v40, v36, v44 offset:29296
    v_mul_u32_u24 v7, s76, v7
    v_lshlrev_b32_sdwa v37, 2, v7 dst_sel:DWORD dst_unused:UNUSED_PAD src0_sel:DWORD src1_sel:BYTE_3
    ds_add_rtn_u32 v41, v37, v44 offset:29296
    v_mul_hi_u32_u24 v4, s77, v4
    v_mad_u32_u24 v34, v34, 40, s82
    v_mul_hi_u32_u24 v5, s77, v5
    v_mad_u32_u24 v35, v35, 40, s82
    v_mul_hi_u32_u24 v6, s77, v6
    v_mad_u32_u24 v36, v36, 40, s82
    v_mul_hi_u32_u24 v7, s77, v7
    v_mad_u32_u24 v37, v37, 40, s82
    s_waitcnt vmcnt(0)
    v_lshl_or_b32 v8, v12, 16, v8
    v_and_or_b32 v9, v12, s83, v9
    v_lshl_or_b32 v10, v13, 16, v10
    v_and_or_b32 v11, v13, s83, v11
    s_waitcnt lgkmcnt(3)
    v_min_u32 v38, 31, v38
    v_add_u32 v42, v34, v38
    v_lshl_add_u32 v43, v38, 2, v34
    ds_write_b8 v42, v4
    ds_write_b32 v43, v8 offset:32
    s_waitcnt lgkmcnt(4)
    v_min_u32 v39, 31, v39
    v_add_u32 v42, v35, v39
    v_lshl_add_u32 v43, v39, 2, v35
    ds_write_b8 v42, v5
    ds_write_b32 v43, v9 offset:32
    s_waitcnt lgkmcnt(5)
    v_min_u32 v40, 31, v40
    v_add_u32 v42, v36, v40
    v_lshl_add_u32 v43, v40, 2, v36
    ds_write_b8 v42, v6
    ds_write_b32 v43, v10 offset:32
    s_waitcnt lgkmcnt(6)
    v_min_u32 v41, 31, v41
    v_add_u32 v42, v37, v41
    v_lshl_add_u32 v43, v41, 2, v37
    ds_write_b8 v42, v7
    ds_write_b32 v43, v11 offset:32
    s_mov_b64 exec, -1
K_PB0:
K_PB:
    s_setprio 2
    s_waitcnt lgkmcnt(0)
    s_barrier
    ds_read_b32 v51, v50 offset:29808
    ds_read_b32 v50, v50 offset:29296
    ds_read_b128 v[4:7], v48
    ds_read_b128 v[8:11], v48 offset:20480
    s_waitcnt lgkmcnt(2)
    v_max_u32 v24, v50, v51
    v_cmp_lt_u32 vcc, 24, v24
    s_cbranch_vccnz K_POV
K_PST:
    s_waitcnt lgkmcnt(1)
    global_store_dwordx4 v[52:53], v[4:7], off sc1
    s_waitcnt lgkmcnt(0)
    global_store_dwordx4 v[54:55], v[8:11], off sc1
K_PH:
    s_setprio 0
    ds_read_b64_tr_b16 v[24:25], v16 offset:0
    ds_read_b64_tr_b16 v[26:27], v16 offset:1024
    ds_read_b128 v[84:87], v84
    ds_read_b128 v[100:103], v100
    ds_read_b64_tr_b16 v[28:29], v16 offset:8192
    ds_read_b64_tr_b16 v[30:31], v16 offset:9216
    ds_read_b128 v[88:91], v88
    ds_read_b128 v[104:107], v104
    ds_read_b64_tr_b16 v[32:33], v16 offset:16384
    ds_read_b64_tr_b16 v[34:35], v16 offset:17408
    ds_read_b128 v[92:95], v92
    ds_read_b128 v[108:111], v108
    s_waitcnt lgkmcnt(9)
    v_mfma_f32_16x16x32_bf16 v[120:123], v[24:27], v[84:87], 0
    s_waitcnt lgkmcnt(8)
    v_mfma_f32_16x16x32_bf16 v[124:127], v[24:27], v[100:103], 0
    ds_read_b64_tr_b16 v[36:37], v16 offset:24576
    ds_read_b64_tr_b16 v[38:39], v16 offset:25600
    ds_read_b128 v[96:99], v96
    ds_read_b128 v[112:115], v112
    s_waitcnt lgkmcnt(9)
    v_mfma_f32_16x16x32_bf16 v[120:123], v[28:31], v[88:91], v[120:123]
    s_waitcnt lgkmcnt(8)
    v_mfma_f32_16x16x32_bf16 v[124:127], v[28:31], v[104:107], v[124:127]
    s_waitcnt lgkmcnt(5)
    v_mfma_f32_16x16x32_bf16 v[120:123], v[32:35], v[92:95], v[120:123]
    s_waitcnt lgkmcnt(4)
    v_mfma_f32_16x16x32_bf16 v[124:127], v[32:35], v[108:111], v[124:127]
    s_waitcnt lgkmcnt(1)
    v_mfma_f32_16x16x32_bf16 v[120:123], v[36:39], v[96:99], v[120:123]
    s_waitcnt lgkmcnt(0)
    v_mfma_f32_16x16x32_bf16 v[124:127], v[36:39], v[112:115], v[124:127]
    s_lshl_b32 s76, s2, 6
    s_add_u32 s76, s76, 3301376
    v_add_u32 v2, s76, v0
    s_nop 2
    v_pk_mul_f32 v[40:41], v[120:121], s[80:81] op_sel_hi:[1,0]
    v_pk_mul_f32 v[42:43], v[122:123], s[80:81] op_sel_hi:[1,0]
    v_cvt_pk_bf16_f32 v40, v40, v41
    v_cvt_pk_bf16_f32 v41, v42, v43
    v_pk_mul_f32 v[44:45], v[124:125], s[80:81] op_sel_hi:[1,0]
    v_pk_mul_f32 v[46:47], v[126:127], s[80:81] op_sel_hi:[1,0]
    v_cvt_pk_bf16_f32 v44, v44, v45
    v_cvt_pk_bf16_f32 v45, v46, v47
    v_pk_mul_f32 v[36:37], v[120:121], v[120:121]
    v_pk_fma_f32 v[36:37], v[122:123], v[122:123], v[36:37]
    v_pk_fma_f32 v[36:37], v[124:125], v[124:125], v[36:37]
    v_pk_fma_f32 v[36:37], v[126:127], v[126:127], v[36:37]
    v_add_f32 v36, v36, v37
    v_cmp_ngt_f32 vcc, 0x41f5fdf0, v36
    s_cbranch_vccnz K_FP
K_FPB:
    s_cmp_eq_u32 s3, 14
    s_cbranch_scc1 K_FB
K_FBB:
    s_waitcnt vmcnt(0)
    v_cmp_eq_u32 vcc, 0, v59
    s_cbranch_vccnz K_ZW
K_ZB:
    s_cmp_lg_u32 s3, 14
    s_waitcnt lgkmcnt(0)
    s_barrier
    s_cbranch_scc1 K_F
    global_store_byte v2, v1, s[24:25] sc1
    s_mov_b64 exec, -1
K_F:
    ds_write_b64 v118, v[40:41] offset:0
    ds_write_b64 v119, v[44:45] offset:0
    s_mov_b32 s32, s6
    s_mov_b32 s33, s7
    s_mov_b32 s34, 75000
    s_mov_b32 s35, 0x20000
    s_cmp_ge_u32 s3, 10
    v_lshlrev_b32 v58, 4, v0
    s_cbranch_scc1 K_JOB
    s_lshr_b32 s76, s2, 7
    s_mul_i32 s76, s76, 9
    s_cmp_lt_u32 s3, s76
    s_cbranch_scc1 K_PD_E
    s_lshl_b32 s76, s3, 13
    s_add_u32 m0, s76, 73984
    s_cmp_eq_u32 s3, 9
    buffer_load_dwordx4 v58, s[32:35], s76 offen lds
    s_cselect_b64 exec, 0xffff, -1
    buffer_load_dwordx4 v58, s[32:35], s76 offen offset:1024 lds
    s_mov_b64 exec, -1
    s_cbranch_scc1 K_PD_E
    buffer_load_dwordx4 v58, s[32:35], s76 offen offset:2048 lds
    buffer_load_dwordx4 v58, s[32:35], s76 offen offset:3072 lds
    s_add_u32 m0, m0, 4096
    s_add_u32 s76, s76, 4096
    buffer_load_dwordx4 v58, s[32:35], s76 offen offset:0 lds
    buffer_load_dwordx4 v58, s[32:35], s76 offen offset:1024 lds
    buffer_load_dwordx4 v58, s[32:35], s76 offen offset:2048 lds
    buffer_load_dwordx4 v58, s[32:35], s76 offen offset:3072 lds
K_PD_E:
    v_lshlrev_b32 v24, 18, v18
    v_or_b32 v25, 0x18000, v24
    v_or_b32 v26, 0x28000, v24
    v_or_b32 v27, 0x38000, v24
    v_or_b32 v24, 0x8000, v24
    s_mov_b32 s80, 0x72000000
    s_mov_b32 s81, 0x3f7f47db
    v_pk_mul_f32 v[26:27], v[26:27], s[80:81] op_sel_hi:[1,0]
    v_pk_mul_f32 v[24:25], v[24:25], s[80:81] op_sel_hi:[1,0]
    v_exp_f32 v28, v24
    v_exp_f32 v29, v25
    v_exp_f32 v30, v26
    v_exp_f32 v31, v27
    v_pk_mul_f32 v[24:25], v[24:25], s[80:81] op_sel:[0,1] op_sel_hi:[1,1]
    v_pk_mul_f32 v[26:27], v[26:27], s[80:81] op_sel:[0,1] op_sel_hi:[1,1]
    v_pk_add_f32 v[28:29], v[28:29], 1.0 op_sel_hi:[1,0]
    v_pk_add_f32 v[30:31], v[30:31], 1.0 op_sel_hi:[1,0]
    v_rcp_f32 v28, v28
    v_rcp_f32 v29, v29
    v_rcp_f32 v30, v30
    v_rcp_f32 v31, v31
    v_lshlrev_b32 v32, 3, v18
    v_add_u32 v33, 0x10000, v32
    v_pk_mul_f32 v[28:29], v[28:29], v[24:25]
    v_pk_mul_f32 v[30:31], v[30:31], v[26:27]
    v_pk_add_f32 v[24:25], v[28:29], v[24:25] neg_lo:[0,1] neg_hi:[0,1]
    v_pk_add_f32 v[26:27], v[30:31], v[26:27] neg_lo:[0,1] neg_hi:[0,1]
    v_cvt_pk_bf16_f32 v28, v28, v29
    v_cvt_pk_bf16_f32 v29, v30, v31
    v_cvt_pk_bf16_f32 v24, v24, v25
    v_cvt_pk_bf16_f32 v25, v26, v27
    ds_write_b64 v32, v[28:29] offset:256
    ds_write_b64 v33, v[24:25] offset:256
K_LL:
    s_mov_b64 s[40:41], 0
    s_mov_b64 s[42:43], 0
    s_mov_b32 s47, 0
    s_mov_b32 s48, 1
    s_mov_b32 s49, -1
    s_movk_i32 s51, 1024
    s_lshr_b32 s76, s2, 7
    s_cmp_eq_u32 s3, 15
    s_cselect_b32 s69, s76, 0
    s_mov_b32 s63, 0
    s_cmp_ge_u32 s3, 10
    s_cbranch_scc1 K_JB2
K_G0:
    s_lshl_b32 s77, s44, 3
    v_and_b32 v9, -8, v18
    v_lshlrev_b32 v8, 2, v18
    v_mad_u32_u24 v8, v9, 12, v8
    v_subrev_u32 v6, s77, v18
    v_and_b32 v6, 1023, v6
    v_cmp_gt_u32 vcc, 1000, v6
    v_lshrrev_b32 v6, 3, v18
    v_mov_b32 v17, 0xbfbfbfbf
    s_and_b32 s84, vcc_lo, 0x3f3f3f3f
    s_and_b32 s85, vcc_hi, 0x3f3f3f3f
    s_setprio 2
    s_waitcnt vmcnt(0) lgkmcnt(0)
    s_barrier
    s_cmp_eq_u32 s69, 0
    s_cbranch_scc1 K_QG
    s_mov_b32 s69, 0
    s_mov_b64 exec, 1
    global_store_dword v56, v57, s[24:25] sc1
    s_mov_b64 exec, -1
K_QG:
    s_mov_b64 exec, vcc
    global_load_dword v17, v8, s[36:37] sc1
    s_mov_b64 exec, s[84:85]
    global_load_dwordx4 v[20:23], v19, s[36:37] offset:32 sc1
    s_mov_b64 exec, -1
    ds_read_u8 v38, v6 offset:65408
    s_setprio 0
K_B0:
    s_lshl_b32 s76, s3, 12
    s_add_u32 s70, s76, 73984
    s_mov_b32 s64, 0xc000
    s_movk_i32 s65, 128
    s_movk_i32 s68, 192
    s_movk_i32 s66, 256
    s_movk_i32 s67, 256
    s_mov_b32 s74, 0
    s_mov_b32 s75, 0xffff0000
    s_add_u32 s71, s70, 1024
    s_add_u32 s72, s70, 2048
    s_add_u32 s73, s70, 3072
    v_and_b32 v34, 15, v0
    v_lshrrev_b32 v35, 4, v0
    v_lshrrev_b32 v36, 3, v34
    v_lshlrev_b32 v36, 1, v36
    v_xor_b32 v36, v36, v35
    v_lshl_add_u32 v36, v36, 4, s70
    v_lshl_add_u32 v1, v34, 6, v36
    v_and_b32 v36, 2, v35
    v_and_b32 v37, 3, v0
    v_xor_b32 v36, v36, v37
    v_lshlrev_b32 v2, 4, v36
    s_waitcnt lgkmcnt(0)
    v_cmp_ne_u32 vcc, 0, v38
    s_cbranch_vccnz K_OL
K_OLB:
    v_cndmask_b32 v3, 2, 0, s[74:75]
    v_mov_b32 v9, 256
    v_cndmask_b32 v8, 0, v9, s[74:75]
    v_mov_b32 v16, 0xdd
    s_and_b32 s76, s3, 7
    s_lshl_b32 s76, s76, 6
    s_add_u32 s76, s76, 31344
    v_and_b32 v36, -4, v0
    v_add_u32 v116, s76, v36
    v_mov_b32 v19, 1
    s_mov_b32 s76, 3313664
    v_lshl_add_u32 v59, v0, 6, s76
    v_mov_b32 v48, 73984
    s_mov_b32 s78, 0x40000
    s_mov_b32 s79, 0x0c040100
    s_and_b32 s76, s3, 7
    s_lshl_b32 s76, s76, 12
    s_add_u32 s87, s76, 3252224
    s_waitcnt vmcnt(0)
K_RW:
    v_lshlrev_b32_sdwa v24, 2, sext(v17) dst_sel:DWORD dst_unused:UNUSED_PAD src0_sel:DWORD src1_sel:BYTE_0
    ds_add_rtn_u32 v28, v24, v19 offset:0
    v_lshlrev_b32_sdwa v25, 2, sext(v17) dst_sel:DWORD dst_unused:UNUSED_PAD src0_sel:DWORD src1_sel:BYTE_1
    ds_add_rtn_u32 v29, v25, v19 offset:0
    v_lshlrev_b32_sdwa v26, 2, sext(v17) dst_sel:DWORD dst_unused:UNUSED_PAD src0_sel:DWORD src1_sel:BYTE_2
    ds_add_rtn_u32 v30, v26, v19 offset:0
    v_lshlrev_b32_sdwa v27, 2, sext(v17) dst_sel:DWORD dst_unused:UNUSED_PAD src0_sel:DWORD src1_sel:BYTE_3
    ds_add_rtn_u32 v31, v27, v19 offset:0
    v_cmp_eq_u32 vcc, -1, v17
    v_and_or_b32 v34, v24, s78, v48
    v_perm_b32 v32, v24, v20, s79
    v_mad_u32_u16 v34, v20, 6, v34
    v_and_b32 v33, 0xffff0000, v20
    v_and_b32 v34, -4, v34
    v_and_or_b32 v38, v25, s78, v48
    v_perm_b32 v36, v25, v21, s79
    v_mad_u32_u16 v38, v21, 6, v38
    v_and_b32 v37, 0xffff0000, v21
    v_and_b32 v38, -4, v38
    v_and_or_b32 v42, v26, s78, v48
    v_perm_b32 v40, v26, v22, s79
    v_mad_u32_u16 v42, v22, 6, v42
    v_and_b32 v41, 0xffff0000, v22
    v_and_b32 v42, -4, v42
    v_and_or_b32 v46, v27, s78, v48
    v_perm_b32 v44, v27, v23, s79
    v_mad_u32_u16 v46, v23, 6, v46
    v_and_b32 v45, 0xffff0000, v23
    v_and_b32 v46, -4, v46
    s_cbranch_vccnz K_OVF
K_OVFB:
    v_lshlrev_b32 v49, 2, v0
    s_cmp_ge_u32 s3, 13
    s_waitcnt lgkmcnt(0)
    s_barrier
    s_cbranch_scc1 K_OWN1
K_OWN1B:
    ds_read_b32 v49, v49 offset:0
    buffer_load_dwordx4 v[60:63], v58, s[24:27], s87 offen offset:0
    buffer_load_dwordx4 v[64:67], v58, s[24:27], s87 offen offset:1024
    ds_read2_b32 v[34:35], v34 offset1:1
    ds_read2_b32 v[38:39], v38 offset1:1
    ds_read2_b32 v[42:43], v42 offset1:1
    ds_read2_b32 v[46:47], v46 offset1:1
    s_waitcnt lgkmcnt(4)
    v_cmp_ne_u32 vcc, 0, v49
    s_mov_b32 s76, 196608
    s_and_b32 s77, vcc_hi, 0xf00000
    s_cbranch_scc1 K_MASK
K_MASKB:
    v_mov_b32 v4, v49
    s_nop 1
    v_add_u32_dpp v4, v4, v4 row_shr:1 row_mask:0xf bank_mask:0xf
    s_nop 1
    v_add_u32_dpp v4, v4, v4 row_shr:2 row_mask:0xf bank_mask:0xf
    s_nop 1
    v_add_u32_dpp v4, v4, v4 row_shr:4 row_mask:0xf bank_mask:0xf
    s_nop 1
    v_add_u32_dpp v4, v4, v4 row_shr:8 row_mask:0xf bank_mask:0xf
    s_nop 1
    v_add_u32_dpp v4, v4, v4 row_bcast:15 row_mask:0xa bank_mask:0xf
    s_nop 1
    v_add_u32_dpp v4, v4, v4 row_bcast:31 row_mask:0xc bank_mask:0xf
    v_sub_u32 v49, v4, v49
    v_readlane_b32 s52, v4, 63
    v_lshlrev_b32 v49, 4, v49
    v_writelane_b32 v49, s76, 63
    ds_bpermute_b32 v24, v24, v49
    ds_bpermute_b32 v25, v25, v49
    ds_bpermute_b32 v26, v26, v49
    ds_bpermute_b32 v27, v27, v49
    s_cmp_gt_u32 s52, 2016
    s_cbranch_scc1 K_SHRINK
    s_cmp_lg_u32 s3, 14
    s_cbranch_scc1 K_QE
    global_load_dword v53, v59, s[24:25] offset:-4096 sc1
    global_load_dword v54, v59, s[24:25] offset:0 sc1
K_QE:
    buffer_load_dwordx4 v[68:71], v58, s[24:27], s87 offen offset:2048
    buffer_load_dwordx4 v[72:75], v58, s[24:27], s87 offen offset:3072
    s_add_u32 s76, s52, 15
    s_lshr_b32 s76, s76, 4
    s_lshr_b32 s77, s76, 4
    s_and_b32 s76, s76, 15
    s_mul_i32 s53, s77, s3
    s_min_u32 s78, s3, s76
    s_add_u32 s53, s53, s78
    s_cmp_lt_u32 s3, s76
    s_addc_u32 s79, s77, 0
    s_lshl_b32 s53, s53, 4
    s_lshl_b32 s79, s79, 4
    s_add_u32 s54, s53, s79
    s_min_u32 s55, s54, s52
    s_waitcnt lgkmcnt(3)
    v_lshl_add_u32 v24, v28, 4, v24
    ds_write_b128 v24, v[32:35] offset:32704
    s_waitcnt lgkmcnt(3)
    v_lshl_add_u32 v25, v29, 4, v25
    ds_write_b128 v25, v[36:39] offset:32704
    s_waitcnt lgkmcnt(3)
    v_lshl_add_u32 v26, v30, 4, v26
    ds_write_b128 v26, v[40:43] offset:32704
    s_waitcnt lgkmcnt(3)
    v_lshl_add_u32 v27, v31, 4, v27
    ds_write_b128 v27, v[44:47] offset:32704
    v_cmp_ge_u32 vcc, s53, v4
    v_cmp_gt_u32 s[84:85], s55, v4
    v_add_u32 v24, 64, v0
    v_cmp_gt_u32 s[86:87], s79, v0
    v_cmp_gt_u32 s[88:89], s79, v24
    s_bcnt1_i32_b64 s56, vcc
    s_bcnt1_i32_b64 s61, s[84:85]
    s_mov_b32 s57, s56
    s_lshl_b32 s76, s53, 4
    s_add_u32 s76, s76, 32704
    v_and_b32 v18, -4, v0
    v_and_b32 v19, 15, v0
    v_lshl_add_u32 v10, v18, 2, s76
    v_lshl_add_u32 v11, v19, 4, s76
    s_cmp_lt_u32 s53, s54
    s_cselect_b64 s[80:81], -1, 0
    s_add_u32 s77, s53, 16
    s_cmp_lt_u32 s77, s54
    s_cselect_b64 s[82:83], -1, 0
    v_add_u32 v19, 256, v10
    v_cndmask_b32 v18, v116, v10, s[80:81]
    v_cndmask_b32 v19, v116, v19, s[82:83]
    v_mov_b32 v24, 196608
    v_lshl_add_u32 v117, v0, 4, s76
    v_add_u32 v118, 1024, v117
    v_cndmask_b32 v117, v24, v117, s[86:87]
    v_cndmask_b32 v118, v24, v118, s[88:89]
    s_cmp_eq_u32 s79, 0
    s_cselect_b32 s60, 6144, s56
    s_cmp_eq_u32 s3, 0
    s_cselect_b32 s76, 48, s60
    s_cselect_b32 s60, 64, s60
    s_lshl_b32 s76, s76, 4
    s_add_u32 s76, s76, s3
    s_lshl_b32 s76, s76, 1
    v_mov_b32 v25, s76
    v_mov_b32 v26, 0x3f80
    s_mov_b64 exec, 1
    ds_write_b16 v25, v26 offset:26880
    s_mov_b64 exec, -1
    s_cmp_ge_u32 s3, 13
    s_cbranch_scc1 K_PAD
K_PADB:
    s_waitcnt vmcnt(0) lgkmcnt(0)
    s_barrier
    v_mov_b32 v42, 0
    ds_read_b32 v17, v42 offset:28460
    ds_read_b32 v13, v18
    ds_read_b32 v14, v19
    ds_read_b32 v12, v11
    ds_read_b32 v15, v11 offset:256
    s_mov_b32 m0, s70
    s_waitcnt lgkmcnt(3)
    v_readfirstlane_b32 s76, v17
    v_mad_u32_u16 v5, v13, s66, v2
    s_cmp_lt_u32 s76, s48
    s_cbranch_scc1 K_ND
    s_mov_b32 s48, 2
    buffer_load_dwordx4 v5, s[24:27], 0 offen lds
    s_mov_b32 m0, s71
    s_nop 0
    buffer_load_dwordx4 v5, s[24:27], 64 offen lds
    s_mov_b32 m0, s72
    s_nop 0
    buffer_load_dwordx4 v5, s[24:27], s65 offen lds
    s_mov_b32 m0, s73
    s_nop 0
    buffer_load_dwordx4 v5, s[24:27], s68 offen lds
K_ND:
    s_cmp_lg_u32 s63, 0
    s_cbranch_scc1 K_GH3
    s_mov_b32 s63, 1
    s_cmp_ge_u32 s3, 8
    s_cbranch_scc1 K_GH1
    v_mfma_f32_16x16x32_bf16 v[120:123], v[60:63], v[84:87], 0
    v_mfma_f32_16x16x32_bf16 v[124:127], v[60:63], v[100:103], 0
    v_mfma_f32_16x16x32_bf16 v[120:123], v[64:67], v[88:91], v[120:123]
    v_mfma_f32_16x16x32_bf16 v[124:127], v[64:67], v[104:107], v[124:127]
    v_mfma_f32_16x16x32_bf16 v[120:123], v[68:71], v[92:95], v[120:123]
    v_mfma_f32_16x16x32_bf16 v[124:127], v[68:71], v[108:111], v[124:127]
    v_mfma_f32_16x16x32_bf16 v[120:123], v[72:75], v[96:99], v[120:123]
    v_mfma_f32_16x16x32_bf16 v[124:127], v[72:75], v[112:115], v[124:127]
    s_branch K_GH2
K_GH1:
    v_mfma_f32_16x16x32_bf16 v[120:123], v[60:63], v[84:87], 0
    v_mfma_f32_16x16x32_bf16 v[124:127], v[100:103], v[60:63], 0
    v_mfma_f32_16x16x32_bf16 v[120:123], v[64:67], v[88:91], v[120:123]
    v_mfma_f32_16x16x32_bf16 v[124:127], v[104:107], v[64:67], v[124:127]
    v_mfma_f32_16x16x32_bf16 v[120:123], v[68:71], v[92:95], v[120:123]
    v_mfma_f32_16x16x32_bf16 v[124:127], v[108:111], v[68:71], v[124:127]
    v_mfma_f32_16x16x32_bf16 v[120:123], v[72:75], v[96:99], v[120:123]
    v_mfma_f32_16x16x32_bf16 v[124:127], v[112:115], v[72:75], v[124:127]
K_GH2:
    s_mov_b32 s80, 0xbfb82566
    s_nop 6
    v_pk_mul_f32 v[120:121], v[120:121], s[80:81] op_sel_hi:[1,0]
    v_pk_mul_f32 v[122:123], v[122:123], s[80:81] op_sel_hi:[1,0]
    v_pk_mul_f32 v[124:125], v[124:125], s[80:81] op_sel_hi:[1,0]
    v_pk_mul_f32 v[126:127], v[126:127], s[80:81] op_sel_hi:[1,0]
K_GH3:
    ds_read_b64 v[40:41], v42 offset:29288
    ds_read_b128 v[20:23], v117
    ds_read_b128 v[24:27], v118
    v_mov_b32 v43, 0
    v_bfe_u32 v17, v0, 2, 2
    v_lshrrev_b32 v18, 4, v0
    v_cmp_eq_u32 vcc, v17, v18
    v_mov_b32 v18, 0x3f80
    v_mov_b32 v19, 0
    v_cndmask_b32 v18, 0, v18, vcc
    v_lshlrev_b32 v17, 4, v0
    v_lshlrev_b64 v[62:63], v17, v[18:19]
    s_waitcnt lgkmcnt(1)
    v_lshlrev_b32_sdwa v28, 2, v20 dst_sel:DWORD dst_unused:UNUSED_PAD src0_sel:DWORD src1_sel:WORD_1
    ds_read_b128 v[28:31], v28 offset:31856
    s_waitcnt lgkmcnt(1)
    v_lshlrev_b32_sdwa v32, 2, v24 dst_sel:DWORD dst_unused:UNUSED_PAD src0_sel:DWORD src1_sel:WORD_1
    ds_read_b128 v[32:35], v32 offset:31856
    v_mfma_f32_16x16x16_bf16 v[84:87], v[42:43], v[42:43], 0
    v_mov_b64 v[68:69], v[62:63]
    v_mfma_f32_16x16x16_bf16 v[88:91], v[42:43], v[42:43], 0
    v_mov_b64 v[74:75], v[62:63]
    v_mfma_f32_16x16x16_bf16 v[92:95], v[42:43], v[42:43], 0
    v_mov_b64 v[80:81], v[62:63]
    v_mfma_f32_16x16x16_bf16 v[96:99], v[42:43], v[42:43], 0
    v_mfma_f32_16x16x16_bf16 v[100:103], v[42:43], v[42:43], 0
    v_mfma_f32_16x16x16_bf16 v[104:107], v[42:43], v[42:43], 0
    v_mfma_f32_16x16x16_bf16 v[108:111], v[42:43], v[42:43], 0
    v_mfma_f32_16x16x16_bf16 v[112:115], v[42:43], v[42:43], 0
    v_lshlrev_b32 v38, 4, v20
    v_alignbit_b32 v37, v23, v22, v38
    v_lshrrev_b32_sdwa v23, v38, v23 dst_sel:WORD_1 dst_unused:UNUSED_PAD src0_sel:DWORD src1_sel:DWORD
    v_lshlrev_b32 v36, 16, v37
    v_and_b32 v37, 0xffff0000, v37
    s_waitcnt lgkmcnt(1)
    v_pk_add_f32 v[28:29], v[28:29], v[36:37] neg_lo:[0,1] neg_hi:[0,1]
    v_sub_f32 v30, v30, v23
    v_mul_f32 v31, v28, v28
    v_fmac_f32 v31, v29, v29
    v_fmac_f32 v31, v30, v30
    v_cvt_pk_bf16_f32 v22, 1.0, v28
    v_mul_f32 v31, 0xbfb8aa3b, v31
    v_cvt_pk_bf16_f32 v23, v29, v30
    v_cmp_nlt_f32 vcc, abs(v21), v41
    v_cmp_nlt_f32 s[80:81], abs(v31), v40
    v_cvt_pk_bf16_f32 v21, v31, v21
    ds_write_b128 v117, v[20:23]
    s_or_b64 vcc, vcc, s[80:81]
    s_and_b64 s[86:87], s[86:87], vcc
    v_lshlrev_b32 v38, 4, v24
    v_alignbit_b32 v37, v27, v26, v38
    v_lshrrev_b32_sdwa v27, v38, v27 dst_sel:WORD_1 dst_unused:UNUSED_PAD src0_sel:DWORD src1_sel:DWORD
    v_lshlrev_b32 v36, 16, v37
    v_and_b32 v37, 0xffff0000, v37
    s_waitcnt lgkmcnt(1)
    v_pk_add_f32 v[32:33], v[32:33], v[36:37] neg_lo:[0,1] neg_hi:[0,1]
    v_sub_f32 v34, v34, v27
    v_mul_f32 v35, v32, v32
    v_fmac_f32 v35, v33, v33
    v_fmac_f32 v35, v34, v34
    v_cvt_pk_bf16_f32 v26, 1.0, v32
    v_mul_f32 v35, 0xbfb8aa3b, v35
    v_cvt_pk_bf16_f32 v27, v33, v34
    v_cmp_nlt_f32 vcc, abs(v25), v41
    v_cmp_nlt_f32 s[80:81], abs(v35), v40
    v_cvt_pk_bf16_f32 v25, v35, v25
    ds_write_b128 v118, v[24:27]
    s_or_b64 vcc, vcc, s[80:81]
    s_and_b64 s[88:89], s[88:89], vcc
    s_or_b64 s[86:87], s[86:87], s[88:89]
    s_cselect_b32 s62, 1, 0
K_XFR:
    s_cmp_ge_u32 s53, s54
    v_mad_u32_u16 v5, v13, s66, v2
    s_cbranch_scc1 K_QW
    v_lshrrev_b32 v17, 2, v0
    v_and_b32 v18, 3, v0
    v_add_u32 v19, s56, v17
    v_mul_u32_u24 v19, 288, v19
    v_add_u32 v19, 149728, v19
    v_lshlrev_b32 v17, 8, v17
    v_add_u32 v17, 26736, v17
    v_cndmask_b32 v19, v19, v17, s[74:75]
    s_mov_b32 vcc_lo, 0
    s_mov_b32 vcc_hi, 0x00ff0000
    v_mov_b32 v17, 196608
    v_lshl_add_u32 v19, v18, 3, v19
    v_cndmask_b32 v19, v19, v17, vcc
    ds_read_b64_tr_b16 v[60:61], v19 offset:0
    ds_read_b64_tr_b16 v[64:65], v19 offset:32
    ds_read_b64_tr_b16 v[66:67], v19 offset:64
    ds_read_b64_tr_b16 v[70:71], v19 offset:96
    ds_read_b64_tr_b16 v[72:73], v19 offset:128
    ds_read_b64_tr_b16 v[76:77], v19 offset:160
    ds_read_b64_tr_b16 v[78:79], v19 offset:192
    ds_read_b64_tr_b16 v[82:83], v19 offset:224
    s_lshl_b32 s76, s56, 3
    s_sub_u32 s76, 29808, s76
    v_and_b32 v19, 48, v0
    v_lshlrev_b32 v19, 1, v19
    v_sub_u32 v19, s76, v19
    v_cndmask_b32 v6, v19, v11, s[74:75]
    v_mad_u32_u16 v12, v12, v3, v6 op_sel:[1,0,0,0]
    ds_read_b64 v[44:45], v12
    ds_read_b64 v[50:51], v12
    ds_read_b64 v[56:57], v12
    v_subrev_u32 v18, s57, v18
    v_and_b32 v18, 3, v18
    v_add_u32 v18, s57, v18
    v_mul_u32_u24 v18, 196608, v18
    v_sub_u32 v18, v10, v18
    v_add_u32 v7, 8, v18
    v_mad_u32_u16 v13, v13, s64, v7 op_sel:[1,0,0,0]
    v_mfma_f32_16x16x16_bf16 v[24:27], v[42:43], v[42:43], 0
    v_mfma_f32_16x16x16_bf16 v[36:39], v[42:43], v[42:43], 0
    v_lshl_add_u64 v[6:7], v[6:7], 0, v[8:9]
    v_add_u32 v10, 512, v10
    v_add_u32 v11, 256, v11
    s_add_u32 s76, s57, 3
    v_readlane_b32 s58, v4, s76
    s_sub_u32 s77, s54, 32
    s_cmp_ge_u32 s58, s55
    s_cselect_b32 s58, 0x7fffffff, s58
    s_sub_u32 s76, s58, 15
    s_min_i32 s59, s76, s77
K_QW:
    s_mov_b32 m0, s70
    s_cmp_eq_u32 s48, 2
    s_cbranch_scc1 K_DM2
    s_cmp_eq_u32 s48, 0
    s_cbranch_scc1 K_DMA
    s_cmp_eq_u32 s3, 14
    s_cbranch_scc1 K_QP
K_QB:
    s_barrier
K_DMA:
    buffer_load_dwordx4 v5, s[24:27], 0 offen lds
    s_mov_b32 m0, s71
    s_nop 0
    buffer_load_dwordx4 v5, s[24:27], 64 offen lds
    s_mov_b32 m0, s72
    s_nop 0
    buffer_load_dwordx4 v5, s[24:27], s65 offen lds
    s_mov_b32 m0, s73
    s_nop 0
    buffer_load_dwordx4 v5, s[24:27], s68 offen lds
K_DM2:
    s_mov_b32 s48, 0
    s_cmp_ge_u32 s53, s54
    s_cbranch_scc1 K_NT0
    ds_read_b32 v17, v42 offset:29284
    v_mad_u32_u16 v5, v14, s66, v2
    s_mov_b32 m0, s70
    s_waitcnt vmcnt(3)
    ds_read_b128 v[46:49], v1 offset:0
    s_waitcnt vmcnt(2)
    ds_read_b128 v[52:55], v1 offset:1024
    s_waitcnt lgkmcnt(1)
    v_mfma_f32_16x16x32_bf16 v[20:23], v[44:47], v[60:63], 0
    buffer_load_dwordx4 v5, s[24:27], 0 offen lds
    v_readfirstlane_b32 s76, v17
    s_or_b32 s62, s62, s76
    s_waitcnt lgkmcnt(0)
K_EV2:
    s_add_u32 s76, s53, 32
    s_cmp_lt_u32 s76, s54
    s_cbranch_scc1 K_GO
    v_mov_b32 v10, v116
K_GO:
    s_cmp_lg_u32 s62, 0
    s_cbranch_scc1 K_LOOPF
K_LOOP:
    v_mfma_f32_16x16x32_bf16 v[28:31], v[48:51], v[62:65], 0
    s_setprio 1
    v_exp_f32 v34, v20
    v_smfmac_f32_16x16x32_bf16 v[108:111], v[42:43], v[24:27], v16
    v_exp_f32 v35, v21
    s_waitcnt lgkmcnt(6)
    v_mfma_f32_16x16x32_bf16 v[24:27], v[50:53], v[66:69], 0
    v_exp_f32 v32, v22
    s_waitcnt lgkmcnt(0)
    v_smfmac_f32_16x16x32_bf16 v[112:115], v[42:43], v[36:39], v16
    v_exp_f32 v33, v23
    s_mov_b32 m0, s71
    v_lshlrev_b32_sdwa v28, 1, v28 dst_sel:DWORD dst_unused:UNUSED_PAD src0_sel:DWORD src1_sel:WORD_1
    v_lshlrev_b32_sdwa v29, 1, v29 dst_sel:DWORD dst_unused:UNUSED_PAD src0_sel:DWORD src1_sel:WORD_1
    v_lshlrev_b32_sdwa v30, 1, v30 dst_sel:DWORD dst_unused:UNUSED_PAD src0_sel:DWORD src1_sel:WORD_1
    v_lshlrev_b32_sdwa v31, 1, v31 dst_sel:DWORD dst_unused:UNUSED_PAD src0_sel:DWORD src1_sel:WORD_1
    v_mad_u32_u16 v12, v15, v3, v6 op_sel:[1,0,0,0]
    v_pk_add_f32 v[34:35], v[34:35], 1.0 op_sel_hi:[1,0]
    v_pk_fma_f32 v[40:41], v[34:35], v[32:33], v[34:35]
    v_pk_fma_f32 v[32:33], v[20:21], v[32:33], v[20:21]
    v_rcp_f32 v40, v40
    v_rcp_f32 v41, v41
    s_setprio 0
    v_pk_mul_f32 v[34:35], v[22:23], v[34:35]
    v_pk_mul_f32 v[20:21], v[32:33], v[40:41]
    v_pk_mul_f32 v[22:23], v[34:35], v[40:41]
    s_waitcnt vmcnt(2)
    ds_read_b64_tr_b16 v[42:43], v13
    ds_read_b128 v[46:49], v1 offset:2048
    ds_read_u16_d16_hi v36, v28 offset:256
    ds_read_u16_d16_hi v37, v29 offset:256
    ds_read_u16_d16_hi v38, v30 offset:256
    ds_read_u16_d16_hi v39, v31 offset:256
    buffer_load_dwordx4 v5, s[24:27], 64 offen lds
    v_mfma_f32_16x16x32_bf16 v[28:31], v[54:57], v[68:71], 0
    s_setprio 1
    v_exp_f32 v34, v24
    s_waitcnt lgkmcnt(5)
    v_smfmac_f32_16x16x32_bf16 v[84:87], v[42:43], v[20:23], v16
    v_exp_f32 v35, v25
    s_waitcnt lgkmcnt(4)
    v_mfma_f32_16x16x32_bf16 v[20:23], v[44:47], v[72:75], 0
    v_exp_f32 v32, v26
    s_waitcnt lgkmcnt(0)
    v_smfmac_f32_16x16x32_bf16 v[88:91], v[42:43], v[36:39], v16
    v_exp_f32 v33, v27
    s_mov_b32 m0, s72
    v_lshlrev_b32_sdwa v28, 1, v28 dst_sel:DWORD dst_unused:UNUSED_PAD src0_sel:DWORD src1_sel:WORD_1
    v_lshlrev_b32_sdwa v29, 1, v29 dst_sel:DWORD dst_unused:UNUSED_PAD src0_sel:DWORD src1_sel:WORD_1
    v_lshlrev_b32_sdwa v30, 1, v30 dst_sel:DWORD dst_unused:UNUSED_PAD src0_sel:DWORD src1_sel:WORD_1
    v_lshlrev_b32_sdwa v31, 1, v31 dst_sel:DWORD dst_unused:UNUSED_PAD src0_sel:DWORD src1_sel:WORD_1
    v_mad_u32_u16 v13, v14, s64, v7 op_sel:[1,0,0,0]
    v_pk_add_f32 v[34:35], v[34:35], 1.0 op_sel_hi:[1,0]
    v_pk_fma_f32 v[40:41], v[34:35], v[32:33], v[34:35]
    v_pk_fma_f32 v[32:33], v[24:25], v[32:33], v[24:25]
    v_rcp_f32 v40, v40
    v_rcp_f32 v41, v41
    s_setprio 0
    v_pk_mul_f32 v[34:35], v[26:27], v[34:35]
    v_pk_mul_f32 v[24:25], v[32:33], v[40:41]
    v_pk_mul_f32 v[26:27], v[34:35], v[40:41]
    s_waitcnt vmcnt(2)
    ds_read_b128 v[52:55], v1 offset:3072
    ds_read_b64 v[44:45], v12
    ds_read_b32 v14, v10
    ds_read_u16_d16_hi v36, v28 offset:256
    ds_read_u16_d16_hi v37, v29 offset:256
    ds_read_u16_d16_hi v38, v30 offset:256
    ds_read_u16_d16_hi v39, v31 offset:256
    buffer_load_dwordx4 v5, s[24:27], s65 offen lds
    v_mfma_f32_16x16x32_bf16 v[28:31], v[48:51], v[74:77], 0
    s_setprio 1
    v_exp_f32 v34, v20
    v_smfmac_f32_16x16x32_bf16 v[92:95], v[42:43], v[24:27], v16
    v_exp_f32 v35, v21
    s_waitcnt lgkmcnt(6)
    v_mfma_f32_16x16x32_bf16 v[24:27], v[50:53], v[78:81], 0
    v_exp_f32 v32, v22
    s_waitcnt lgkmcnt(0)
    v_smfmac_f32_16x16x32_bf16 v[96:99], v[42:43], v[36:39], v16
    v_exp_f32 v33, v23
    s_mov_b32 m0, s73
    v_lshlrev_b32_sdwa v28, 1, v28 dst_sel:DWORD dst_unused:UNUSED_PAD src0_sel:DWORD src1_sel:WORD_1
    v_lshlrev_b32_sdwa v29, 1, v29 dst_sel:DWORD dst_unused:UNUSED_PAD src0_sel:DWORD src1_sel:WORD_1
    v_lshlrev_b32_sdwa v30, 1, v30 dst_sel:DWORD dst_unused:UNUSED_PAD src0_sel:DWORD src1_sel:WORD_1
    v_lshlrev_b32_sdwa v31, 1, v31 dst_sel:DWORD dst_unused:UNUSED_PAD src0_sel:DWORD src1_sel:WORD_1
    v_lshl_add_u64 v[10:11], v[10:11], 0, s[66:67]
    v_lshl_add_u64 v[6:7], v[6:7], 0, v[8:9]
    v_pk_add_f32 v[34:35], v[34:35], 1.0 op_sel_hi:[1,0]
    v_pk_fma_f32 v[40:41], v[34:35], v[32:33], v[34:35]
    v_pk_fma_f32 v[32:33], v[20:21], v[32:33], v[20:21]
    v_rcp_f32 v40, v40
    s_add_u32 s53, s53, 16
    v_rcp_f32 v41, v41
    s_setprio 0
    v_pk_mul_f32 v[34:35], v[22:23], v[34:35]
    v_pk_mul_f32 v[20:21], v[32:33], v[40:41]
    v_pk_mul_f32 v[22:23], v[34:35], v[40:41]
    s_waitcnt vmcnt(2)
    ds_read_b128 v[46:49], v1 offset:0
    ds_read_b64 v[50:51], v12
    ds_read_u16_d16_hi v36, v28 offset:256
    ds_read_u16_d16_hi v37, v29 offset:256
    ds_read_u16_d16_hi v38, v30 offset:256
    ds_read_u16_d16_hi v39, v31 offset:256
    buffer_load_dwordx4 v5, s[24:27], s68 offen lds
    v_mfma_f32_16x16x32_bf16 v[28:31], v[54:57], v[80:83], 0
    s_setprio 1
    v_exp_f32 v34, v24
    v_smfmac_f32_16x16x32_bf16 v[100:103], v[42:43], v[20:23], v16
    v_exp_f32 v35, v25
    s_waitcnt lgkmcnt(5)
    v_mfma_f32_16x16x32_bf16 v[20:23], v[44:47], v[60:63], 0
    v_exp_f32 v32, v26
    s_waitcnt lgkmcnt(0)
    v_smfmac_f32_16x16x32_bf16 v[104:107], v[42:43], v[36:39], v16
    v_exp_f32 v33, v27
    s_mov_b32 m0, s70
    v_lshlrev_b32_sdwa v28, 1, v28 dst_sel:DWORD dst_unused:UNUSED_PAD src0_sel:DWORD src1_sel:WORD_1
    v_lshlrev_b32_sdwa v29, 1, v29 dst_sel:DWORD dst_unused:UNUSED_PAD src0_sel:DWORD src1_sel:WORD_1
    v_lshlrev_b32_sdwa v30, 1, v30 dst_sel:DWORD dst_unused:UNUSED_PAD src0_sel:DWORD src1_sel:WORD_1
    v_lshlrev_b32_sdwa v31, 1, v31 dst_sel:DWORD dst_unused:UNUSED_PAD src0_sel:DWORD src1_sel:WORD_1
    v_mad_u32_u16 v5, v14, s66, v2
    v_pk_add_f32 v[34:35], v[34:35], 1.0 op_sel_hi:[1,0]
    v_pk_fma_f32 v[40:41], v[34:35], v[32:33], v[34:35]
    v_pk_fma_f32 v[32:33], v[24:25], v[32:33], v[24:25]
    v_rcp_f32 v40, v40
    s_cmp_lt_i32 s53, s59
    v_rcp_f32 v41, v41
    s_setprio 0
    v_pk_mul_f32 v[34:35], v[26:27], v[34:35]
    v_pk_mul_f32 v[24:25], v[32:33], v[40:41]
    v_pk_mul_f32 v[26:27], v[34:35], v[40:41]
    s_waitcnt vmcnt(2)
    ds_read_b128 v[52:55], v1 offset:1024
    ds_read_b64 v[56:57], v12
    ds_read_b32 v15, v11
    ds_read_u16_d16_hi v36, v28 offset:256
    ds_read_u16_d16_hi v37, v29 offset:256
    ds_read_u16_d16_hi v38, v30 offset:256
    ds_read_u16_d16_hi v39, v31 offset:256
    buffer_load_dwordx4 v5, s[24:27], 0 offen lds
    s_cbranch_scc1 K_LOOP
K_EV:
    s_add_u32 s76, s53, 16
    s_cmp_lt_u32 s58, s76
    s_cbranch_scc1 K_WIN
    s_cmp_lt_u32 s53, s54
    s_cbranch_scc1 K_EV2
    s_lshr_b32 s79, s3, 3
    s_and_b32 s78, s3, 7
    s_lshl_b32 s78, s78, 5
    s_lshl_b32 s76, s79, 12
    s_add_u32 s76, s76, s78
    v_and_b32 v5, 15, v0
    v_and_b32 v6, 48, v0
    v_lshrrev_b32 v8, 1, v6
    v_lshl_add_u32 v17, v5, 8, v8
    v_lshl_add_u32 v10, v5, 1, s78
    s_add_u32 s76, s76, 4096
    s_movk_i32 s77, 12288
    s_cmp_lg_u32 s79, 0
    buffer_load_dwordx2 v[68:69], v17, s[28:31], s76 offen
    s_cbranch_scc1 K_XA1
    buffer_load_dwordx2 v[70:71], v17, s[28:31], s78 offen
    s_branch K_XA2
K_XA1:
    buffer_load_ushort v70, v10, s[28:31], s77 offen
K_XA2:
    s_mov_b32 s69, 1
    s_movk_i32 s63, 64
K_FLUSH:
    v_and_b32 v17, 15, v0
    v_lshlrev_b32 v18, 5, v17
    ds_read_b128 v[32:35], v18 offset:30832
    s_waitcnt lgkmcnt(1)
    v_smfmac_f32_16x16x32_bf16 v[108:111], v[42:43], v[24:27], v16
    v_smfmac_f32_16x16x32_bf16 v[112:115], v[42:43], v[36:39], v16
    ds_read_b128 v[28:31], v18 offset:30848
    v_lshrrev_b32 v18, 4, v0
    v_subrev_u32 v18, s57, v18
    v_and_b32 v18, 3, v18
    v_add_u32 v18, s57, v18
    s_add_u32 s76, s61, 1
    s_min_u32 s76, s76, s63
    s_add_u32 s77, s3, 48
    v_cmp_eq_u32 vcc, s60, v18
    v_cmp_gt_u32 s[80:81], s76, v18
    v_cmp_gt_u32 s[82:83], s63, v18
    v_mov_b32 v19, s77
    v_cndmask_b32 v19, v18, v19, vcc
    v_mul_u32_u24 v19, 288, v19
    v_lshl_add_u32 v19, v17, 4, v19
    v_lshl_add_u32 v18, v18, 4, v17
    v_cvt_pk_bf16_f32 v24, v84, v88
    v_cvt_pk_bf16_f32 v25, v92, v96
    v_cvt_pk_bf16_f32 v26, v100, v104
    v_cvt_pk_bf16_f32 v27, v108, v112
    s_mov_b64 exec, s[80:81]
    ds_write_b128 v19, v[24:27] offset:8448
    s_mov_b64 exec, -1
    s_waitcnt lgkmcnt(1)
    v_pk_mul_f32 v[38:39], v[86:87], v[32:33] op_sel_hi:[1,0]
    v_mul_f32 v37, v85, v32
    v_pk_fma_f32 v[38:39], v[90:91], v[32:33], v[38:39] op_sel:[0,1,0] op_sel_hi:[1,1,1]
    v_fmac_f32 v37, v89, v33
    v_pk_fma_f32 v[38:39], v[94:95], v[34:35], v[38:39] op_sel:[0,0,0] op_sel_hi:[1,0,1]
    v_fmac_f32 v37, v93, v34
    v_pk_fma_f32 v[38:39], v[98:99], v[34:35], v[38:39] op_sel:[0,1,0] op_sel_hi:[1,1,1]
    v_fmac_f32 v37, v97, v35
    v_pk_fma_f32 v[38:39], v[102:103], v[28:29], v[38:39] op_sel:[0,0,0] op_sel_hi:[1,0,1]
    v_fmac_f32 v37, v101, v28
    v_pk_fma_f32 v[38:39], v[106:107], v[28:29], v[38:39] op_sel:[0,1,0] op_sel_hi:[1,1,1]
    v_fmac_f32 v37, v105, v29
    v_pk_fma_f32 v[38:39], v[110:111], v[30:31], v[38:39] op_sel:[0,0,0] op_sel_hi:[1,0,1]
    v_fmac_f32 v37, v109, v30
    v_pk_fma_f32 v[38:39], v[114:115], v[30:31], v[38:39] op_sel:[0,1,0] op_sel_hi:[1,1,1]
    v_fmac_f32 v37, v113, v31
    s_and_b32 s80, s80, 0x01110111
    v_add_f32_dpp v38, v38, v38 row_ror:8 row_mask:0xf bank_mask:0xf
    v_add_f32_dpp v37, v37, v37 row_ror:8 row_mask:0xf bank_mask:0x3
    s_and_b32 s81, s81, 0x01110111
    v_add_f32_dpp v38, v38, v38 row_shr:4 row_mask:0xf bank_mask:0x2
    v_add_f32_dpp v37, v39, v39 row_ror:8 row_mask:0xf bank_mask:0xc
    s_nop 1
    v_add_f32_dpp v38, v37, v37 row_shl:4 row_mask:0xf bank_mask:0x5
    s_nop 1
    v_add_f32_dpp v38, v38, v38 quad_perm:[1,0,3,2] row_mask:0xf bank_mask:0xf
    s_nop 1
    v_add_f32_dpp v38, v38, v38 quad_perm:[2,3,0,1] row_mask:0xf bank_mask:0xf
    s_mov_b64 exec, s[80:81]
    ds_add_f32 v18, v38 offset:28448
    s_mov_b64 exec, -1
    s_cmp_eq_u32 s69, 0
    s_cbranch_scc1 K_SLIDE
    s_waitcnt vmcnt(3)
K_POST:
    ds_read_b128 v[76:79], v1 offset:2048
    ds_read_b128 v[80:83], v1 offset:3072
    s_mul_i32 s76, s79, 4608
    v_mul_u32_u24 v2, 288, v5
    v_add_u32 v2, v2, v6
    v_add_u32 v1, s76, v2
    s_lshl_b32 s76, s79, 9
    v_lshl_add_u32 v11, v5, 5, v8
    v_add_u32 v3, s76, v11
    s_mul_i32 s76, s79, 1536
    v_add_u32 v11, s76, v11
    s_mul_i32 s76, s79, 4352
    s_add_u32 s76, s76, s78
    s_add_u32 s76, s76, 73984
    v_mul_u32_u24 v4, 272, v5
    v_add3_u32 v4, v4, v8, s76
    v_add_u32 v10, 87040, v10
    s_mov_b32 s80, 0x3f805c55
    s_mov_b32 s81, 0xbf317218
    s_cmp_lg_u32 s79, 0
    s_waitcnt vmcnt(2) lgkmcnt(0)
    s_barrier
    ds_read_b128 v[84:87], v2 offset:22272
    ds_read_b128 v[88:91], v2 offset:22336
    ds_read_b128 v[92:95], v2 offset:22400
    ds_read_b128 v[96:99], v2 offset:22464
    ds_read_b128 v[100:103], v1 offset:13056
    ds_read_b128 v[104:107], v1 offset:13120
    ds_read_b128 v[108:111], v1 offset:13184
    ds_read_b128 v[112:115], v1 offset:13248
    ds_read_b64 v[74:75], v3 offset:27392
    ds_read_b64 v[56:57], v11 offset:26880
    s_cbranch_scc1 K_E1
    ds_read_b128 v[20:23], v2 offset:8448
    ds_read_b128 v[24:27], v2 offset:8512
    ds_read_b128 v[28:31], v2 offset:8576
    ds_read_b128 v[32:35], v2 offset:8640
    s_waitcnt lgkmcnt(13)
    v_mfma_f32_16x16x32_bf16 v[36:39], v[84:87], v[46:49], 0
    s_waitcnt lgkmcnt(12)
    v_mfma_f32_16x16x32_bf16 v[36:39], v[88:91], v[52:55], v[36:39]
    s_waitcnt lgkmcnt(11)
    v_mfma_f32_16x16x32_bf16 v[36:39], v[92:95], v[76:79], v[36:39]
    s_waitcnt lgkmcnt(10)
    v_mfma_f32_16x16x32_bf16 v[36:39], v[96:99], v[80:83], v[36:39]
    s_waitcnt lgkmcnt(9)
    v_mfma_f32_16x16x32_bf16 v[120:123], v[46:49], v[100:103], v[120:123]
    s_waitcnt lgkmcnt(8)
    v_mfma_f32_16x16x32_bf16 v[120:123], v[52:55], v[104:107], v[120:123]
    s_waitcnt lgkmcnt(7)
    v_mfma_f32_16x16x32_bf16 v[120:123], v[76:79], v[108:111], v[120:123]
    s_waitcnt lgkmcnt(6)
    v_mfma_f32_16x16x32_bf16 v[120:123], v[80:83], v[112:115], v[120:123]
    v_cvt_pk_bf16_f32 v40, v36, v37
    v_cvt_pk_bf16_f32 v41, v38, v39
    s_waitcnt lgkmcnt(3)
    v_mfma_f32_16x16x32_bf16 v[124:127], v[46:49], v[20:23], v[124:127]
    s_waitcnt lgkmcnt(2)
    v_mfma_f32_16x16x32_bf16 v[124:127], v[52:55], v[24:27], v[124:127]
    s_waitcnt lgkmcnt(1)
    v_mfma_f32_16x16x32_bf16 v[124:127], v[76:79], v[28:31], v[124:127]
    v_mfma_f32_16x16x16_bf16 v[120:123], v[40:41], v[74:75], v[120:123]
    s_waitcnt lgkmcnt(0)
    v_mfma_f32_16x16x32_bf16 v[124:127], v[80:83], v[32:35], v[124:127]
    s_cmp_lg_u32 s47, 0
    s_waitcnt vmcnt(0)
    v_lshlrev_b32 v60, 16, v68
    v_and_b32 v61, 0xffff0000, v68
    v_lshlrev_b32 v62, 16, v69
    v_and_b32 v63, 0xffff0000, v69
    v_lshlrev_b32 v64, 16, v70
    v_and_b32 v65, 0xffff0000, v70
    v_lshlrev_b32 v66, 16, v71
    v_and_b32 v67, 0xffff0000, v71
    v_mfma_f32_16x16x16_bf16 v[124:127], v[40:41], v[56:57], v[124:127]
    s_cbranch_scc1 K_NEXT
K_S0:
    v_pk_mul_f32 v[120:121], v[120:121], s[80:81] op_sel_hi:[1,0]
    v_pk_mul_f32 v[122:123], v[122:123], s[80:81] op_sel_hi:[1,0]
    v_exp_f32 v20, v120
    v_exp_f32 v21, v121
    v_exp_f32 v22, v122
    v_exp_f32 v23, v123
    v_pk_add_f32 v[20:21], v[20:21], 1.0 op_sel_hi:[1,0]
    v_pk_add_f32 v[22:23], v[22:23], 1.0 op_sel_hi:[1,0]
    v_rcp_f32 v20, v20
    v_rcp_f32 v21, v21
    v_rcp_f32 v22, v22
    v_rcp_f32 v23, v23
    v_pk_mul_f32 v[120:121], v[120:121], s[80:81] op_sel:[0,1] op_sel_hi:[1,1]
    v_pk_mul_f32 v[122:123], v[122:123], s[80:81] op_sel:[0,1] op_sel_hi:[1,1]
    v_pk_fma_f32 v[120:121], v[120:121], v[20:21], v[60:61]
    v_pk_fma_f32 v[122:123], v[122:123], v[22:23], v[62:63]
    v_cvt_pk_bf16_f32 v120, v120, v121
    v_cvt_pk_bf16_f32 v121, v122, v123
    ds_write_b64 v4, v[120:121] offset:4352
    v_pk_mul_f32 v[124:125], v[124:125], s[80:81] op_sel_hi:[1,0]
    v_pk_mul_f32 v[126:127], v[126:127], s[80:81] op_sel_hi:[1,0]
    v_exp_f32 v20, v124
    v_exp_f32 v21, v125
    v_exp_f32 v22, v126
    v_exp_f32 v23, v127
    v_pk_add_f32 v[20:21], v[20:21], 1.0 op_sel_hi:[1,0]
    v_pk_add_f32 v[22:23], v[22:23], 1.0 op_sel_hi:[1,0]
    v_rcp_f32 v20, v20
    v_rcp_f32 v21, v21
    v_rcp_f32 v22, v22
    v_rcp_f32 v23, v23
    v_pk_mul_f32 v[124:125], v[124:125], s[80:81] op_sel:[0,1] op_sel_hi:[1,1]
    v_pk_mul_f32 v[126:127], v[126:127], s[80:81] op_sel:[0,1] op_sel_hi:[1,1]
    v_pk_fma_f32 v[124:125], v[124:125], v[20:21], v[64:65]
    v_pk_fma_f32 v[126:127], v[126:127], v[22:23], v[66:67]
    v_cvt_pk_bf16_f32 v124, v124, v125
    v_cvt_pk_bf16_f32 v125, v126, v127
    ds_write_b64 v4, v[124:125]
K_OUT:
    s_lshl_b32 s78, s45, 8
    s_add_u32 s32, s20, s78
    s_addc_u32 s33, s21, 0
    s_lshl_b32 s34, s46, 8
    s_mov_b32 s35, 0x20000
    s_lshl_b32 s76, s3, 10
    v_lshl_add_u32 v7, v0, 4, s76
    s_lshl_b32 s76, s3, 6
    s_add_u32 s76, s76, 73984
    v_add3_u32 v8, v7, v6, s76
    s_cmp_ge_u32 s3, 13
    s_waitcnt lgkmcnt(0)
    s_barrier
    s_cbranch_scc1 K_FIN
    ds_read_b128 v[20:23], v8
    s_waitcnt lgkmcnt(0)
    buffer_store_dwordx4 v[20:23], v7, s[32:35], 0 offen sc1
K_FIN:
K_END:
    s_endpgm
K_E1:
    s_waitcnt lgkmcnt(9)
    v_mfma_f32_16x16x32_bf16 v[36:39], v[84:87], v[46:49], 0
    s_waitcnt lgkmcnt(8)
    v_mfma_f32_16x16x32_bf16 v[36:39], v[88:91], v[52:55], v[36:39]
    s_waitcnt lgkmcnt(7)
    v_mfma_f32_16x16x32_bf16 v[36:39], v[92:95], v[76:79], v[36:39]
    s_waitcnt lgkmcnt(6)
    v_mfma_f32_16x16x32_bf16 v[36:39], v[96:99], v[80:83], v[36:39]
    s_waitcnt lgkmcnt(5)
    v_mfma_f32_16x16x32_bf16 v[120:123], v[46:49], v[100:103], v[120:123]
    s_waitcnt lgkmcnt(4)
    v_mfma_f32_16x16x32_bf16 v[120:123], v[52:55], v[104:107], v[120:123]
    s_waitcnt lgkmcnt(3)
    v_mfma_f32_16x16x32_bf16 v[120:123], v[76:79], v[108:111], v[120:123]
    s_waitcnt lgkmcnt(2)
    v_mfma_f32_16x16x32_bf16 v[120:123], v[80:83], v[112:115], v[120:123]
    v_cvt_pk_bf16_f32 v40, v36, v37
    v_cvt_pk_bf16_f32 v41, v38, v39
    s_waitcnt lgkmcnt(0)
    s_cmp_lg_u32 s47, 0
    v_mfma_f32_16x16x16_bf16 v[124:127], v[56:57], v[40:41], v[124:127]
    s_waitcnt vmcnt(0)
    v_lshlrev_b32 v60, 16, v68
    v_and_b32 v61, 0xffff0000, v68
    v_lshlrev_b32 v62, 16, v69
    v_and_b32 v63, 0xffff0000, v69
    v_mfma_f32_16x16x16_bf16 v[120:123], v[40:41], v[74:75], v[120:123]
    v_lshlrev_b32 v64, 16, v70
    s_cbranch_scc1 K_NEXT
K_S1:
    s_sub_u32 s76, s3, 13
    s_lshl_b32 s76, s76, 6
    v_add_u32 v11, s76, v0
    v_mul_u32_u24 v12, 171, v11
    v_lshrrev_b32 v12, 9, v12
    v_add_lshl_u32 v13, v11, v12, 2
    ds_read_b32 v14, v13 offset:28448
    ds_read_b32 v15, v13 offset:31856
    v_pk_mul_f32 v[120:121], v[120:121], s[80:81] op_sel_hi:[1,0]
    v_pk_mul_f32 v[122:123], v[122:123], s[80:81] op_sel_hi:[1,0]
    v_exp_f32 v20, v120
    v_exp_f32 v21, v121
    v_exp_f32 v22, v122
    v_exp_f32 v23, v123
    v_pk_add_f32 v[20:21], v[20:21], 1.0 op_sel_hi:[1,0]
    v_pk_add_f32 v[22:23], v[22:23], 1.0 op_sel_hi:[1,0]
    v_rcp_f32 v20, v20
    v_rcp_f32 v21, v21
    v_rcp_f32 v22, v22
    v_rcp_f32 v23, v23
    v_pk_mul_f32 v[120:121], v[120:121], s[80:81] op_sel:[0,1] op_sel_hi:[1,1]
    v_pk_mul_f32 v[122:123], v[122:123], s[80:81] op_sel:[0,1] op_sel_hi:[1,1]
    v_pk_fma_f32 v[120:121], v[120:121], v[20:21], v[60:61]
    v_pk_fma_f32 v[122:123], v[122:123], v[22:23], v[62:63]
    v_cvt_pk_bf16_f32 v120, v120, v121
    v_cvt_pk_bf16_f32 v121, v122, v123
    ds_write_b64 v4, v[120:121] offset:4352
    v_mul_f32 v124, s80, v124
    v_exp_f32 v20, v124
    v_mul_f32 v124, s81, v124
    v_add_f32 v20, 1.0, v20
    v_rcp_f32 v20, v20
    v_cmp_gt_u32 vcc, s46, v12
    v_fmac_f32 v64, v20, v124
    v_cvt_pk_bf16_f32 v64, v64, v64
    s_mov_b64 exec, 0xffff
    ds_write_b16 v10, v64
    s_mov_b64 exec, -1
    s_cmp_lt_u32 s3, 13
    s_cbranch_scc1 K_OUT
    s_mul_i32 s76, s45, 6
    s_add_u32 s76, s76, 3200000
    v_lshl_add_u32 v11, v11, 1, s76
    s_waitcnt lgkmcnt(2)
    v_add_f32 v14, v14, v15
    v_cvt_pk_bf16_f32 v14, v14, v14
    s_mov_b64 exec, vcc
    global_store_short v11, v14, s[20:21] sc1
    s_mov_b64 exec, -1
    s_branch K_OUT
K_NP:
    s_cmp_lt_u32 s2, 128
    s_cbranch_scc1 K_AUX
    s_lshr_b32 s76, s78, 1
    s_mul_i32 s76, s76, 48
    s_lshl_b32 s77, s78, 3
    s_add_u32 s76, s76, s77
    v_lshl_add_u32 v26, v14, 4, s76
    s_movk_i32 s76, 272
    v_mad_u32_u24 v116, v24, s76, v26
    v_mad_u32_u24 v117, v25, s76, v26
    v_lshlrev_b32 v1, 1, v14
    v_xor_b32 v1, v1, v15
    v_lshlrev_b32 v1, 4, v1
    v_lshl_add_u32 v1, v14, 8, v1
    s_bitcmp1_b32 s3, 0
    s_cselect_b32 s76, 0x80, 0
    v_xor_b32 v1, s76, v1
    s_mov_b32 s34, 0x8000
    s_mov_b32 s35, 0x20000
    s_lshl_b32 s76, s45, 8
    v_cmp_gt_u32 vcc, 784, v18
    v_add_u32 v13, s76, v19
    v_subrev_u32 v12, 200704, v13
    v_cndmask_b32 v12, 2.0, v12, vcc
    v_cndmask_b32 v13, 2.0, v13, vcc
    v_and_b32 v17, 0x3f0, v18
    v_add_u32 v17, v17, v19
    v_mov_b64 v[14:15], v[12:13]
    s_cmp_lt_u32 s3, 12
    s_cbranch_scc1 K_NW
    s_cmp_ge_u32 s3, 14
    s_waitcnt vmcnt(1)
    s_cbranch_scc1 K_NW
    s_waitcnt vmcnt(0)
K_NW:
    s_cmp_lg_u32 s3, 14
    s_waitcnt lgkmcnt(0)
    s_barrier
    s_cbranch_scc1 K_NZ
    global_load_dword v59, v58, s[22:23] sc1
K_NZ:
    s_mov_b64 s[32:33], s[14:15]
    s_lshl_b32 s76, s3, 11
    s_add_u32 m0, s76, 106752
    s_nop 0
    buffer_load_dwordx4 v1, s[32:35], s76 offen lds
    buffer_load_dwordx4 v1, s[32:35], s76 offen offset:1024 lds
    ds_read_b64_tr_b16 v[60:61], v16 offset:0
    ds_read_b64_tr_b16 v[62:63], v16 offset:1024
    ds_read_b128 v[84:87], v84
    ds_read_b128 v[100:103], v100
    ds_read_b64_tr_b16 v[64:65], v16 offset:8192
    ds_read_b64_tr_b16 v[66:67], v16 offset:9216
    ds_read_b128 v[88:91], v88
    ds_read_b128 v[104:107], v104
    ds_read_b64_tr_b16 v[68:69], v16 offset:16384
    ds_read_b64_tr_b16 v[70:71], v16 offset:17408
    ds_read_b128 v[92:95], v92
    ds_read_b128 v[108:111], v108
    s_waitcnt lgkmcnt(9)
    v_mfma_f32_16x16x32_bf16 v[76:79], v[60:63], v[84:87], 0
    s_waitcnt lgkmcnt(8)
    v_mfma_f32_16x16x32_bf16 v[80:83], v[60:63], v[100:103], 0
    ds_read_b64_tr_b16 v[72:73], v16 offset:24576
    ds_read_b64_tr_b16 v[74:75], v16 offset:25600
    ds_read_b128 v[96:99], v96
    ds_read_b128 v[112:115], v112
    s_bitcmp0_b32 7984, s3
    s_cbranch_scc1 K_PQ1c
    s_mov_b32 exec_lo, 0x0f0f0f0f
    s_mov_b32 exec_hi, 0x0f0f0f0f
    buffer_store_dwordx4 v[20:23], v13, s[24:27], 0 offen sc1
    s_mov_b64 exec, -1
K_PQ1c:
    s_waitcnt lgkmcnt(9)
    v_mfma_f32_16x16x32_bf16 v[76:79], v[64:67], v[88:91], v[76:79]
    s_waitcnt lgkmcnt(8)
    v_mfma_f32_16x16x32_bf16 v[80:83], v[64:67], v[104:107], v[80:83]
    s_waitcnt lgkmcnt(5)
    v_mfma_f32_16x16x32_bf16 v[76:79], v[68:71], v[92:95], v[76:79]
    s_waitcnt lgkmcnt(4)
    v_mfma_f32_16x16x32_bf16 v[80:83], v[68:71], v[108:111], v[80:83]
    s_waitcnt lgkmcnt(1)
    v_mfma_f32_16x16x32_bf16 v[76:79], v[72:75], v[96:99], v[76:79]
    s_waitcnt lgkmcnt(0)
    v_mfma_f32_16x16x32_bf16 v[80:83], v[72:75], v[112:115], v[80:83]
    v_xor_b32 v84, 0, v56
    v_xor_b32 v100, 0, v57
    v_xor_b32 v88, 64, v56
    v_xor_b32 v104, 64, v57
    v_xor_b32 v92, 128, v56
    v_xor_b32 v108, 128, v57
    v_xor_b32 v96, 192, v56
    v_xor_b32 v112, 192, v57
    v_pk_mul_f32 v[24:25], v[76:77], s[80:81] op_sel_hi:[1,0]
    v_pk_mul_f32 v[26:27], v[78:79], s[80:81] op_sel_hi:[1,0]
    v_cvt_pk_bf16_f32 v24, v24, v25
    v_cvt_pk_bf16_f32 v25, v26, v27
    v_pk_mul_f32 v[28:29], v[80:81], s[80:81] op_sel_hi:[1,0]
    v_pk_mul_f32 v[30:31], v[82:83], s[80:81] op_sel_hi:[1,0]
    v_cvt_pk_bf16_f32 v28, v28, v29
    v_cvt_pk_bf16_f32 v29, v30, v31
    ds_write_b64 v116, v[24:25] offset:46336
    ds_write_b64 v117, v[28:29] offset:46336
    v_pk_mul_f32 v[36:37], v[76:77], v[76:77]
    v_pk_fma_f32 v[36:37], v[78:79], v[78:79], v[36:37]
    v_pk_fma_f32 v[36:37], v[80:81], v[80:81], v[36:37]
    v_pk_fma_f32 v[36:37], v[82:83], v[82:83], v[36:37]
    v_add_f32 v36, v36, v37
    v_cmp_ngt_f32 vcc, 0x41f5fdf0, v36
    s_cbranch_vccnz K_FQ
K_FQB:
    s_mov_b64 s[32:33], s[6:7]
    s_lshl_b32 s77, s3, 10
    s_sub_u32 m0, m0, 32768
    s_bitcmp1_b32 7984, s3
    s_cbranch_scc1 K_PW
    s_waitcnt vmcnt(0)
K_PW:
    s_cmp_lg_u32 s3, 14
    s_waitcnt vmcnt(1) lgkmcnt(0)
    s_barrier
    ds_read_b128 v[48:51], v17 offset:46336
    ds_read_b128 v[84:87], v84
    ds_read_b128 v[100:103], v100
    ds_read_b128 v[88:91], v88
    ds_read_b128 v[104:107], v104
    ds_read_b128 v[92:95], v92
    ds_read_b128 v[108:111], v108
    ds_read_b128 v[96:99], v96
    ds_read_b128 v[112:115], v112
    s_waitcnt lgkmcnt(7)
    buffer_store_dwordx4 v[48:51], v14, s[24:27], 0 offen sc1
    buffer_load_dwordx4 v19, s[32:35], s77 offen lds
    buffer_load_dwordx4 v19, s[32:35], s77 offen offset:1024 lds
    s_add_u32 s79, m0, 32768
    s_mov_b32 s34, 75000
    s_cmp_ge_u32 s3, 8
    s_cbranch_scc1 K_P9
    s_add_u32 m0, s77, 139520
    s_mov_b32 s76, 65536
    buffer_load_dwordx4 v19, s[32:35], s76 offen lds
K_P9:
    s_mov_b32 m0, s79
    s_add_u32 s77, s77, 32768
    ds_read_b64_tr_b16 v[24:25], v16 offset:32768
    ds_read_b64_tr_b16 v[26:27], v16 offset:33792
    ds_read_b64_tr_b16 v[28:29], v16 offset:40960
    ds_read_b64_tr_b16 v[30:31], v16 offset:41984
    ds_read_b64_tr_b16 v[32:33], v16 offset:49152
    ds_read_b64_tr_b16 v[34:35], v16 offset:50176
    ds_read_b64_tr_b16 v[36:37], v16 offset:57344
    ds_read_b64_tr_b16 v[38:39], v16 offset:58368
    s_waitcnt lgkmcnt(15)
    v_mfma_f32_16x16x32_bf16 v[76:79], v[60:63], v[84:87], 0
    s_waitcnt lgkmcnt(14)
    v_mfma_f32_16x16x32_bf16 v[80:83], v[60:63], v[100:103], 0
    s_waitcnt lgkmcnt(13)
    v_mfma_f32_16x16x32_bf16 v[76:79], v[64:67], v[88:91], v[76:79]
    s_waitcnt lgkmcnt(12)
    v_mfma_f32_16x16x32_bf16 v[80:83], v[64:67], v[104:107], v[80:83]
    s_waitcnt lgkmcnt(11)
    v_mfma_f32_16x16x32_bf16 v[76:79], v[68:71], v[92:95], v[76:79]
    s_waitcnt lgkmcnt(10)
    v_mfma_f32_16x16x32_bf16 v[80:83], v[68:71], v[108:111], v[80:83]
    s_waitcnt lgkmcnt(9)
    v_mfma_f32_16x16x32_bf16 v[76:79], v[72:75], v[96:99], v[76:79]
    s_waitcnt lgkmcnt(8)
    v_mfma_f32_16x16x32_bf16 v[80:83], v[72:75], v[112:115], v[80:83]
    s_waitcnt lgkmcnt(6)
    v_mfma_f32_16x16x32_bf16 v[120:123], v[24:27], v[84:87], 0
    v_mfma_f32_16x16x32_bf16 v[124:127], v[24:27], v[100:103], 0
    s_waitcnt lgkmcnt(4)
    v_mfma_f32_16x16x32_bf16 v[120:123], v[28:31], v[88:91], v[120:123]
    v_mfma_f32_16x16x32_bf16 v[124:127], v[28:31], v[104:107], v[124:127]
    s_waitcnt lgkmcnt(2)
    v_mfma_f32_16x16x32_bf16 v[120:123], v[32:35], v[92:95], v[120:123]
    v_mfma_f32_16x16x32_bf16 v[124:127], v[32:35], v[108:111], v[124:127]
    s_waitcnt lgkmcnt(0)
    v_mfma_f32_16x16x32_bf16 v[120:123], v[36:39], v[96:99], v[120:123]
    v_mfma_f32_16x16x32_bf16 v[124:127], v[36:39], v[112:115], v[124:127]
    v_pk_mul_f32 v[4:5], v[76:77], s[80:81] op_sel_hi:[1,0]
    v_pk_mul_f32 v[6:7], v[78:79], s[80:81] op_sel_hi:[1,0]
    v_cvt_pk_bf16_f32 v4, v4, v5
    v_cvt_pk_bf16_f32 v5, v6, v7
    v_pk_mul_f32 v[8:9], v[80:81], s[80:81] op_sel_hi:[1,0]
    v_pk_mul_f32 v[10:11], v[82:83], s[80:81] op_sel_hi:[1,0]
    v_cvt_pk_bf16_f32 v8, v8, v9
    v_cvt_pk_bf16_f32 v9, v10, v11
    ds_write_b64 v116, v[4:5] offset:32768
    ds_write_b64 v117, v[8:9] offset:32768
    v_pk_mul_f32 v[36:37], v[76:77], v[76:77]
    v_pk_fma_f32 v[36:37], v[78:79], v[78:79], v[36:37]
    v_pk_fma_f32 v[36:37], v[80:81], v[80:81], v[36:37]
    v_pk_fma_f32 v[36:37], v[82:83], v[82:83], v[36:37]
    v_add_f32 v36, v36, v37
    v_cmp_ngt_f32 vcc, 0x41f5fdf0, v36
    s_cbranch_vccnz K_FR
K_FRB:
    v_pk_mul_f32 v[40:41], v[120:121], s[80:81] op_sel_hi:[1,0]
    v_pk_mul_f32 v[42:43], v[122:123], s[80:81] op_sel_hi:[1,0]
    v_cvt_pk_bf16_f32 v40, v40, v41
    v_cvt_pk_bf16_f32 v41, v42, v43
    v_pk_mul_f32 v[44:45], v[124:125], s[80:81] op_sel_hi:[1,0]
    v_pk_mul_f32 v[46:47], v[126:127], s[80:81] op_sel_hi:[1,0]
    v_cvt_pk_bf16_f32 v44, v44, v45
    v_cvt_pk_bf16_f32 v45, v46, v47
    v_pk_mul_f32 v[36:37], v[120:121], v[120:121]
    v_pk_fma_f32 v[36:37], v[122:123], v[122:123], v[36:37]
    v_pk_fma_f32 v[36:37], v[124:125], v[124:125], v[36:37]
    v_pk_fma_f32 v[36:37], v[126:127], v[126:127], v[36:37]
    v_add_f32 v36, v36, v37
    v_cmp_ngt_f32 vcc, 0x41f5fdf0, v36
    s_cbranch_vccnz K_FS
K_FSB:
    v_cmp_eq_u32 vcc, 0, v59
    s_cbranch_vccnz K_ZQ
K_X3:
    s_cmp_lg_u32 s3, 14
    s_waitcnt lgkmcnt(0)
    s_barrier
    ds_read_b128 v[52:55], v17 offset:32768
    buffer_load_dwordx4 v19, s[32:35], s77 offen lds
    buffer_load_dwordx4 v19, s[32:35], s77 offen offset:1024 lds
    s_waitcnt lgkmcnt(0)
    buffer_store_dwordx4 v[52:55], v15, s[24:27], 0 offen sc1
    s_branch K_F
K_ZQ:
    s_mov_b32 s76, 262144
    global_load_dword v59, v58, s[22:23] sc1
K_ZR:
    s_waitcnt vmcnt(0)
    v_cmp_eq_u32 vcc, 0, v59
    s_sub_u32 s76, s76, 1
    s_cbranch_vccz K_ZR_E
    s_mov_b64 exec, vcc
    global_load_dword v59, v58, s[22:23] sc1
    s_cbranch_scc0 K_ZR
    s_waitcnt vmcnt(0)
K_ZR_E:
    s_mov_b64 exec, -1
    s_branch K_X3
K_ZW:
    s_mov_b32 s76, 262144
    global_load_dword v59, v58, s[22:23] sc1
K_ZP:
    s_waitcnt vmcnt(0)
    v_cmp_eq_u32 vcc, 0, v59
    s_sub_u32 s76, s76, 1
    s_cbranch_vccz K_ZP_E
    s_mov_b64 exec, vcc
    global_load_dword v59, v58, s[22:23] sc1
    s_cbranch_scc0 K_ZP
    s_waitcnt vmcnt(0)
K_ZP_E:
    s_mov_b64 exec, -1
    s_branch K_ZB
K_AUX:
    s_waitcnt vmcnt(0) lgkmcnt(0)
    s_barrier
    s_branch K_PH
K_PF:
    s_bfe_u32 s76, s2, 0x40003
    s_lshl_b32 s76, s76, 13
    v_lshl_add_u32 v2, v0, 7, s76
    v_min_u32 v2, 74996, v2
    v_lshlrev_b32 v3, 7, v0
    global_load_dword v126, v2, s[6:7]
    s_add_u32 s82, s14, 65536
    s_addc_u32 s83, s15, 0
    s_mov_b64 exec, 15
    global_load_dword v126, v3, s[82:83]
    s_mov_b64 exec, 3
    global_load_dword v126, v3, s[16:17]
    s_mov_b64 exec, -1
    s_branch K_PFB
K_WJ:
    s_cmp_ge_u32 s2, 64
    s_cbranch_scc1 K_LE
    s_and_b32 s78, s2, 28
    s_and_b32 s76, s2, 3
    s_lshl_b32 s78, s78, 3
    v_lshl_add_u32 v24, v15, 1, s78
    s_cmp_ge_u32 s2, 32
    s_cbranch_scc1 K_WJ1
    s_lshl_b32 s78, s76, 10
    s_add_u32 s78, s78, 36864
    v_lshl_add_u32 v24, v14, 8, v24
    v_add_u32 v24, s78, v24
    global_load_ushort v60, v24, s[18:19] offset:-4096
    global_load_ushort v61, v24, s[18:19] offset:0
    v_add_u32 v24, 0x2000, v24
    global_load_ushort v62, v24, s[18:19] offset:-4096
    global_load_ushort v63, v24, s[18:19] offset:0
    v_add_u32 v24, 0x2000, v24
    global_load_ushort v64, v24, s[18:19] offset:-4096
    global_load_ushort v65, v24, s[18:19] offset:0
    v_add_u32 v24, 0x2000, v24
    global_load_ushort v66, v24, s[18:19] offset:-4096
    global_load_ushort v67, v24, s[18:19] offset:0
    s_branch K_CH
K_WJ1:
    s_lshl_b32 s78, s76, 13
    v_lshl_add_u32 v24, v14, 11, v24
    v_add_u32 v24, s78, v24
    global_load_ushort v60, v24, s[18:19] offset:0
    global_load_ushort v61, v24, s[18:19] offset:256
    global_load_ushort v62, v24, s[18:19] offset:512
    global_load_ushort v63, v24, s[18:19] offset:768
    global_load_ushort v64, v24, s[18:19] offset:1024
    global_load_ushort v65, v24, s[18:19] offset:1280
    global_load_ushort v66, v24, s[18:19] offset:1536
    global_load_ushort v67, v24, s[18:19] offset:1792
    s_branch K_CH
K_ZF:
    s_mov_b32 s76, 3305472
    v_lshl_add_u32 v2, v0, 6, s76
    v_add_u32 v3, 0x2000, v2
    v_mov_b32 v4, 0
    v_mov_b32 v5, 1
    v_mov_b64 v[6:7], 0
    s_waitcnt lgkmcnt(0)
    v_lshl_add_u32 v2, v0, 4, s76
    v_mov_b64 v[8:9], 0
    global_store_dwordx4 v2, v[6:9], s[24:25] offset:-4096 sc1
    global_store_dwordx4 v2, v[6:9], s[24:25] offset:-3072 sc1
    global_store_dwordx4 v2, v[6:9], s[24:25] offset:-2048 sc1
    global_store_dwordx4 v2, v[6:9], s[24:25] offset:-1024 sc1
    global_store_dwordx4 v2, v[6:9], s[24:25] offset:0 sc1
    global_store_dwordx4 v2, v[6:9], s[24:25] offset:1024 sc1
    global_store_dwordx4 v2, v[6:9], s[24:25] offset:2048 sc1
    global_store_dwordx4 v2, v[6:9], s[24:25] offset:3072 sc1
    global_store_dwordx2 v3, v[6:7], s[24:25] offset:-4096 sc1
    global_store_dwordx2 v3, v[6:7], s[24:25] sc1
    s_waitcnt vmcnt(0)
    s_mov_b64 exec, 1
    global_store_dword v4, v5, s[22:23] sc1
    s_mov_b64 exec, -1
    s_branch K_LD
K_PLD:
    s_lshl_b32 s76, s3, 8
    s_or_b32 s76, s76, s2
    s_cmp_lt_u32 s76, 3392
    s_cbranch_scc1 K_PL2
    v_cmp_le_u32 vcc, 1016, v18
    s_add_u32 s84, s86, 2146560
    s_addc_u32 s85, s87, 0
    s_mov_b64 exec, vcc
    v_lshl_add_u64 v[54:55], v[46:47], 4, s[84:85]
    s_mov_b64 exec, -1
    s_cmp_eq_u32 s3, 14
    s_waitcnt vmcnt(0)
    s_cbranch_scc0 K_PB0
    global_load_dword v59, v58, s[22:23] sc1
    s_branch K_PB0
K_PL2:
    s_and_b32 s76, s2, 3
    s_mul_i32 s76, s76, -960
    v_lshl_add_u32 v12, v15, 8, s76
    v_lshl_add_u32 v12, v14, 4, v12
    v_lshlrev_b32 v13, 4, v0
    s_cmp_ge_u32 s2, 32
    s_cselect_b64 vcc, -1, 0
    s_lshl_b32 s76, s2, 10
    s_add_u32 s76, s76, 3219456
    v_cndmask_b32 v12, v12, v13, vcc
    v_add_u32 v12, s76, v12
    s_waitcnt vmcnt(0)
    v_lshl_or_b32 v60, v61, 16, v60
    v_lshl_or_b32 v61, v63, 16, v62
    v_lshl_or_b32 v62, v65, 16, v64
    v_lshl_or_b32 v63, v67, 16, v66
    global_store_dwordx4 v12, v[60:63], s[24:25] sc1
    s_branch K_PB0
K_POV:
    ds_read_b128 v[20:23], v48 offset:128
    ds_read_b128 v[24:27], v48 offset:20608
    s_movk_i32 s77, 8320
    s_mov_b32 s82, 0x03030303
    s_mov_b32 s83, 0x03030303
    v_and_b32 v28, -8, v46
    v_lshlrev_b32 v29, 4, v46
    v_mad_i32_i24 v28, v28, -12, v29
    v_lshrrev_b32 v29, 3, v18
    v_mad_u32_u24 v28, v29, s77, v28
    v_add_u32 v28, 16384, v28
    v_add_u32 v29, 1064960, v28
    s_waitcnt lgkmcnt(0)
    v_cmp_lt_u32 vcc, 24, v50
    s_and_b64 exec, vcc, s[82:83]
    s_cbranch_execz K_OV0
    global_store_dwordx4 v28, v[20:23], s[86:87] sc1
    v_cmpx_lt_u32 vcc, 32, v50
    v_mov_b32 v4, -1
    v_mov_b32 v5, -1
    v_mov_b32 v6, -1
    v_mov_b32 v7, -1
K_OV0:
    s_mov_b64 exec, -1
    v_cmp_lt_u32 vcc, 24, v51
    s_and_b64 exec, vcc, s[82:83]
    s_cbranch_execz K_OV1
    global_store_dwordx4 v29, v[24:27], s[86:87] sc1
    v_cmpx_lt_u32 vcc, 32, v51
    v_mov_b32 v8, -1
    v_mov_b32 v9, -1
    v_mov_b32 v10, -1
    v_mov_b32 v11, -1
K_OV1:
    s_mov_b64 exec, -1
    s_branch K_PST
K_FB:
    v_lshlrev_b32 v1, 4, v0
    ds_read_b128 v[20:23], v1 offset:29296
    v_mov_b32 v1, 8
    s_waitcnt lgkmcnt(0)
    v_sub_u32 v23, 24, v23
    v_alignbit_b32 v1, v1, v23, 31
    v_sub_u32 v22, 24, v22
    v_alignbit_b32 v1, v1, v22, 31
    v_sub_u32 v21, 24, v21
    v_alignbit_b32 v1, v1, v21, 31
    v_sub_u32 v20, 24, v20
    v_alignbit_b32 v1, v1, v20, 31
    s_branch K_FBB
K_OL:
    s_mul_i32 s76, s44, 8320
    s_add_u32 s76, s76, 4210592
    v_and_b32 v38, -8, v18
    v_mad_i32_i24 v38, v38, -12, v19
    v_add_u32 v38, s76, v38
    s_and_b32 exec_lo, vcc_lo, 0xc0c0c0c0
    s_and_b32 exec_hi, vcc_hi, 0xc0c0c0c0
    global_load_dwordx4 v[20:23], v38, s[24:25] sc1
    s_mov_b64 exec, -1
    s_branch K_OLB
K_FQ:
    v_mov_b32 v36, 29280
    v_mov_b32 v37, 0x10000
    ds_write_b32 v36, v37
    s_branch K_FQB
K_FR:
    v_mov_b32 v36, 29280
    v_mov_b32 v37, 0x10000
    ds_write_b32 v36, v37
    s_branch K_FRB
K_FP:
    v_mov_b32 v36, 29284
    ds_write_b32 v36, v36
    s_branch K_FPB
K_FS:
    v_mov_b32 v36, 29284
    ds_write_b32 v36, v36
    s_branch K_FSB
K_JO2:
    s_mul_i32 s76, s44, 8320
    s_add_u32 s76, s76, 4210688
    v_lshl_add_u32 v4, v0, 6, s76
    global_load_dword v4, v4, s[24:25] sc1
    s_branch K_PD_E
K_JOB:
    s_cmp_eq_u32 s3, 15
    s_cbranch_scc1 K_PD_E
    s_cmp_eq_u32 s3, 14
    s_cbranch_scc1 K_PD_E
    s_cmp_lt_u32 s3, 13
    s_cbranch_scc1 K_JB1
    v_cmp_eq_u32 vcc, 32, v0
    v_cmp_eq_u32 s[82:83], 33, v0
    v_mov_b32 v12, 0x3f80
    v_lshlrev_b32 v4, 4, v0
    v_cndmask_b32 v8, 0, v12, vcc
    v_cndmask_b32 v9, 0, v12, s[82:83]
    v_lshlrev_b32 v10, 16, v8
    v_lshlrev_b32 v11, 16, v9
    ds_write_b128 v4, v[8:11] offset:29296
    v_lshlrev_b32 v4, 3, v0
    v_lshlrev_b32 v12, 1, v0
    v_add_u32 v12, 12576, v12
    v_add_u32 v13, 1, v12
    ds_write_b64 v4, v[12:13] offset:31344
    s_branch K_PD_E
K_JB1:
    s_lshl_b32 s76, s3, 8
    s_add_u32 s76, s76, 62976
    s_add_u32 s82, s14, s76
    s_addc_u32 s83, s15, 0
    s_cmp_eq_u32 s3, 12
    s_cselect_b64 s[82:83], s[16:17], s[82:83]
    v_lshlrev_b32 v4, 2, v0
    global_load_dword v10, v4, s[82:83]
    s_branch K_PD_E
K_JB2:
    s_cmp_ge_u32 s3, 13
    s_cbranch_scc1 K_JB4
    s_cmp_eq_u32 s3, 12
    v_lshrrev_b32 v8, 3, v0
    s_waitcnt vmcnt(0)
    v_and_b32 v11, 0xffff0000, v10
    v_lshlrev_b32 v10, 16, v10
    s_cbranch_scc1 K_JB3
    s_cmp_eq_u32 s3, 10
    s_cselect_b32 s76, 1.0, 0xbfb8aa3b
    s_mov_b32 s77, 0x41700000
    s_cmov_b32 s77, 0x42000000
    v_mul_f32 v10, s76, v10
    v_mul_f32 v11, s76, v11
    v_and_b32 v12, 0x7fffffff, v10
    v_and_b32 v13, 0x7fffffff, v11
    v_max_u32 v12, v12, v13
    v_and_b32 v8, 1, v8
    v_mul_i32_i24 v8, -101, v8
    v_ldexp_f32 v10, v10, v8
    v_ldexp_f32 v11, v11, v8
    v_cvt_pk_bf16_f32 v10, v10, v11
    s_lshl_b32 s76, s3, 8
    v_add_u32 v4, s76, v4
    ds_write_b32 v4, v10 offset:27760
    s_nop 1
    v_max_u32_dpp v12, v12, v12 row_shr:1 row_mask:0xf bank_mask:0xf
    s_nop 1
    v_max_u32_dpp v12, v12, v12 row_shr:2 row_mask:0xf bank_mask:0xf
    s_nop 1
    v_max_u32_dpp v12, v12, v12 row_shr:4 row_mask:0xf bank_mask:0xf
    s_nop 1
    v_max_u32_dpp v12, v12, v12 row_shr:8 row_mask:0xf bank_mask:0xf
    s_nop 1
    v_max_u32_dpp v12, v12, v12 row_bcast:15 row_mask:0xa bank_mask:0xf
    s_nop 1
    v_max_u32_dpp v12, v12, v12 row_bcast:31 row_mask:0xc bank_mask:0xf
    s_lshl_b32 s76, s3, 2
    v_rcp_f32 v12, v12
    v_mov_b32 v4, s76
    v_mul_f32 v12, s77, v12
    s_mov_b32 exec_lo, 0
    s_brev_b32 exec_hi, 1
    ds_write_b32 v4, v12 offset:29248
    s_mov_b64 exec, -1
    s_branch K_G0
K_JB3:
    v_mul_f32 v10, 0xbf31f218, v10
    v_mul_f32 v11, 0xbf31f218, v11
    v_and_b32 v4, 7, v0
    v_lshlrev_b32 v4, 6, v4
    v_lshl_add_u32 v4, v8, 2, v4
    ds_write_b32 v4, v10 offset:30832
    ds_write_b32 v4, v11 offset:30864
    s_branch K_G0
K_JB4:
    v_mov_b32 v57, 0
    ds_read_b32 v57, v57 offset:29280
    s_lshl_b32 s76, s2, 6
    s_cmp_lt_u32 s2, 128
    s_cselect_b32 s77, 8196, 0
    s_add_u32 s76, s76, s77
    s_add_u32 s76, s76, 3301376
    v_mov_b32 v56, s76
    s_cmp_eq_u32 s3, 14
    s_waitcnt lgkmcnt(0)
    v_or_b32 v57, 1, v57
    s_cbranch_scc0 K_G0
    s_and_b32 s76, s44, 3
    s_lshl_b32 s77, 1, s76
    v_cmp_gt_u32 vcc, 61, v0
    v_mov_b32 v12, s77
    v_add_u32 v4, s44, v0
    v_and_b32 v4, 127, v4
    v_cndmask_b32 v12, 0, v12, vcc
    v_xor_b32 v5, 64, v4
    s_lshr_b32 s76, s44, 2
    s_add_u32 s76, s76, 3305472
    v_lshl_add_u32 v8, v0, 6, s76
    s_mov_b32 s76, 262144
    global_load_ubyte v9, v8, s[24:25] offset:-4096 sc1
    global_load_ubyte v10, v8, s[24:25] offset:0 sc1
K_PP:
    s_waitcnt vmcnt(0)
    v_min_u32 v11, v9, v10
    v_cmp_eq_u32 vcc, 0, v11
    s_sub_u32 s76, s76, 1
    s_cbranch_vccz K_PP_E
    s_mov_b64 exec, vcc
    global_load_ubyte v9, v8, s[24:25] offset:-4096 sc1
    global_load_ubyte v10, v8, s[24:25] offset:0 sc1
    s_cbranch_scc0 K_PP
    s_waitcnt vmcnt(0)
K_PP_E:
    s_mov_b64 exec, -1
    v_and_b32 v9, s77, v9
    v_and_b32 v10, v12, v10
    ds_write_b8 v4, v9 offset:65408
    ds_write_b8 v5, v10 offset:65408
    s_branch K_G0
K_OWN1:
    s_cmp_eq_u32 s3, 13
    s_cbranch_scc1 K_OWN0
    s_branch K_OWN1B
K_OWN0:
    v_add_u32 v50, s45, v0
    v_mad_u32_u24 v50, v50, 6, v48
    v_cmp_gt_u32 vcc, s46, v0
    v_mov_b32 v51, 196608
    v_mov_b32 v52, 0
    v_mov_b32 v53, 0
    v_mov_b32 v54, 0
    v_mov_b32 v55, 0
    v_cndmask_b32 v50, v51, v50, vcc
    ds_read_u16_d16_hi v52, v50
    ds_read_u16_d16_hi v53, v50 offset:2
    ds_read_u16_d16_hi v54, v50 offset:4
    s_branch K_OWN1B
K_PAD:
    s_cmp_eq_u32 s3, 14
    s_cbranch_scc1 K_QP0
    s_cmp_eq_u32 s3, 13
    s_cbranch_scc1 K_OWN2
    v_add_lshl_u32 v25, v0, s52, 4
    v_mov_b32 v52, 13643988
    v_mov_b32 v53, 0
    v_mov_b32 v54, 0
    v_mov_b32 v55, 0
    v_cndmask_b32 v25, v25, v24, s[74:75]
    ds_write_b128 v25, v[52:55] offset:32704
    s_branch K_PADB
K_OWN2:
    v_lshlrev_b32 v25, 4, v0
    s_mov_b32 exec_hi, 0x1fffff
    ds_write_b128 v25, v[52:55] offset:31856
    s_mov_b64 exec, -1
    s_branch K_PADB
K_QP0:
    s_mov_b32 s76, 262144
K_QBP:
    s_waitcnt vmcnt(0)
    v_min_u32 v56, v53, v54
    v_cmp_eq_u32 vcc, 0, v56
    s_sub_u32 s76, s76, 1
    s_cbranch_vccz K_QBP_E
    s_mov_b64 exec, vcc
    global_load_dword v53, v59, s[24:25] offset:-4096 sc1
    global_load_dword v54, v59, s[24:25] offset:0 sc1
    s_cbranch_scc0 K_QBP
    s_waitcnt vmcnt(0)
K_QBP_E:
    s_mov_b64 exec, -1
    s_waitcnt vmcnt(0)
    v_min_u32 v56, v53, v54
    v_or_b32 v53, v53, v54
    v_cmp_eq_u32 vcc, 0, v56
    v_mov_b32 v55, 0
    s_cbranch_vccnz K_PADB
    v_cmp_lt_u32 vcc, 0xffff, v53
    ds_write_b32 v55, v9 offset:28460
    s_cbranch_vccz K_PADB
    ds_write_b32 v55, v9 offset:29284
    s_branch K_PADB
K_QP:
    s_mov_b32 s76, 3313664
    v_lshl_add_u32 v32, v0, 6, s76
    s_mov_b32 s76, 262144
    global_load_dword v33, v32, s[24:25] offset:-4096 sc1
    global_load_dword v34, v32, s[24:25] offset:0 sc1
K_QPP:
    s_waitcnt vmcnt(0)
    v_min_u32 v35, v33, v34
    v_cmp_eq_u32 vcc, 0, v35
    s_sub_u32 s76, s76, 1
    s_cbranch_vccz K_QPP_E
    s_mov_b64 exec, vcc
    global_load_dword v33, v32, s[24:25] offset:-4096 sc1
    global_load_dword v34, v32, s[24:25] offset:0 sc1
    s_cbranch_scc0 K_QPP
    s_waitcnt vmcnt(0)
K_QPP_E:
    s_mov_b64 exec, -1
    v_or_b32 v32, v33, v34
    v_cmp_lt_u32 vcc, 0xffff, v32
    s_cbranch_vccz K_QB
    ds_write_b32 v42, v9 offset:29284
    s_waitcnt lgkmcnt(0)
    s_branch K_QB
K_NT0:
    s_waitcnt vmcnt(0)
    ds_read_b128 v[46:49], v1 offset:0
    ds_read_b128 v[52:55], v1 offset:1024
    s_lshr_b32 s79, s3, 3
    s_and_b32 s78, s3, 7
    s_lshl_b32 s78, s78, 5
    s_lshl_b32 s76, s79, 12
    s_add_u32 s76, s76, s78
    v_and_b32 v5, 15, v0
    v_and_b32 v6, 48, v0
    v_lshrrev_b32 v8, 1, v6
    v_lshl_add_u32 v17, v5, 8, v8
    v_lshl_add_u32 v10, v5, 1, s78
    s_add_u32 s76, s76, 4096
    s_movk_i32 s77, 12288
    s_cmp_lg_u32 s79, 0
    buffer_load_dwordx2 v[68:69], v17, s[28:31], s76 offen
    s_cbranch_scc1 K_XB1
    buffer_load_dwordx2 v[70:71], v17, s[28:31], s78 offen
    s_branch K_XB2
K_XB1:
    buffer_load_ushort v70, v10, s[28:31], s77 offen
K_XB2:
    s_branch K_POST
K_WIN:
    s_min_u32 s76, s58, s53
    v_cmp_ge_u32 vcc, s76, v4
    s_mov_b32 s69, 0
    s_bcnt1_i32_b64 s63, vcc
    s_branch K_FLUSH
K_SLIDE:
    v_mov_b32 v42, 0
    v_mov_b32 v43, 0
    v_and_b32 v17, 3, v0
    v_subrev_u32 v18, s57, v17
    v_subrev_u32 v17, s63, v17
    v_and_b32 v18, 3, v18
    v_and_b32 v17, 3, v17
    s_sub_u32 s76, s63, s57
    v_sub_u32 v17, v17, v18
    v_add_u32 v17, s76, v17
    v_mul_u32_u24 v17, 196608, v17
    s_mov_b32 s57, s63
    s_mov_b64 exec, s[82:83]
    v_mov_b64 v[84:85], 0
    v_mov_b64 v[86:87], 0
    v_mov_b64 v[88:89], 0
    v_mov_b64 v[90:91], 0
    v_mov_b64 v[92:93], 0
    v_mov_b64 v[94:95], 0
    v_mov_b64 v[96:97], 0
    v_mov_b64 v[98:99], 0
    v_mov_b64 v[100:101], 0
    v_mov_b64 v[102:103], 0
    v_mov_b64 v[104:105], 0
    v_mov_b64 v[106:107], 0
    v_mov_b64 v[108:109], 0
    v_mov_b64 v[110:111], 0
    v_mov_b64 v[112:113], 0
    v_mov_b64 v[114:115], 0
    s_mov_b64 exec, -1
    s_cmp_lt_u32 s58, s53
    s_cbranch_scc1 K_REDO
    s_sub_u32 s76, s57, s56
    s_cmp_gt_u32 s76, 8
    s_cbranch_scc1 K_RESTART
    v_mfma_f32_16x16x16_bf16 v[24:27], v[42:43], v[42:43], 0
    v_mfma_f32_16x16x16_bf16 v[36:39], v[42:43], v[42:43], 0
    v_sub_u32 v13, v13, v17
    v_sub_u32 v7, v7, v17
    s_add_u32 s76, s57, 3
    v_readlane_b32 s58, v4, s76
    s_sub_u32 s77, s54, 32
    s_cmp_ge_u32 s58, s55
    s_cselect_b32 s58, 0x7fffffff, s58
    s_sub_u32 s76, s58, 15
    s_min_i32 s59, s76, s77
    s_branch K_EV2
K_REDO:
    s_sub_u32 s53, s53, 16
K_RESTART:
    s_mov_b32 s56, s57
    s_lshl_b32 s76, s53, 4
    s_add_u32 s76, s76, 32704
    v_and_b32 v18, -4, v0
    v_and_b32 v19, 15, v0
    v_lshl_add_u32 v10, v18, 2, s76
    v_lshl_add_u32 v11, v19, 4, s76
    s_cmp_lt_u32 s53, s54
    s_cselect_b64 s[80:81], -1, 0
    s_add_u32 s77, s53, 16
    s_cmp_lt_u32 s77, s54
    s_cselect_b64 s[82:83], -1, 0
    v_add_u32 v19, 256, v10
    v_cndmask_b32 v18, v116, v10, s[80:81]
    v_cndmask_b32 v19, v116, v19, s[82:83]
    s_waitcnt vmcnt(0) lgkmcnt(0)
    ds_read_b32 v13, v18
    ds_read_b32 v14, v19
    ds_read_b32 v12, v11
    ds_read_b32 v15, v11 offset:256
    s_waitcnt lgkmcnt(0)
    s_branch K_XFR
K_LOOPF:
    s_waitcnt lgkmcnt(3)
    v_mfma_f32_16x16x32_bf16 v[28:31], v[48:51], v[62:65], 0
    v_smfmac_f32_16x16x32_bf16 v[108:111], v[42:43], v[24:27], v16
    s_waitcnt lgkmcnt(2)
    v_mfma_f32_16x16x32_bf16 v[24:27], v[50:53], v[66:69], 0
    v_smfmac_f32_16x16x32_bf16 v[112:115], v[42:43], v[36:39], v16
    v_exp_f32 v32, v20
    v_exp_f32 v33, v21
    v_exp_f32 v34, v22
    v_exp_f32 v35, v23
    v_pk_add_f32 v[32:33], v[32:33], 1.0 op_sel_hi:[1,0]
    v_pk_add_f32 v[34:35], v[34:35], 1.0 op_sel_hi:[1,0]
    v_rcp_f32 v32, v32
    v_rcp_f32 v33, v33
    v_rcp_f32 v34, v34
    v_rcp_f32 v35, v35
    v_pk_mul_f32 v[20:21], v[32:33], v[20:21]
    v_pk_mul_f32 v[22:23], v[34:35], v[22:23]
    v_mul_f32 v28, 0x72000000, v28
    v_mul_f32 v29, 0x72000000, v29
    v_mul_f32 v30, 0x72000000, v30
    v_mul_f32 v31, 0x72000000, v31
    v_exp_f32 v32, v28
    v_exp_f32 v33, v29
    v_exp_f32 v34, v30
    v_exp_f32 v35, v31
    v_pk_add_f32 v[32:33], v[32:33], 1.0 op_sel_hi:[1,0]
    v_pk_add_f32 v[34:35], v[34:35], 1.0 op_sel_hi:[1,0]
    v_rcp_f32 v32, v32
    v_rcp_f32 v33, v33
    v_rcp_f32 v34, v34
    v_rcp_f32 v35, v35
    v_pk_mul_f32 v[36:37], v[32:33], v[28:29]
    v_pk_mul_f32 v[38:39], v[34:35], v[30:31]
    s_waitcnt lgkmcnt(0)
    v_mad_u32_u16 v12, v15, v3, v6 op_sel:[1,0,0,0]
    s_mov_b32 m0, s71
    s_waitcnt vmcnt(2)
    ds_read_b64_tr_b16 v[42:43], v13
    ds_read_b128 v[46:49], v1 offset:2048
    buffer_load_dwordx4 v5, s[24:27], 64 offen lds
    v_mfma_f32_16x16x32_bf16 v[28:31], v[54:57], v[68:71], 0
    s_waitcnt lgkmcnt(1)
    v_smfmac_f32_16x16x32_bf16 v[84:87], v[42:43], v[20:23], v16
    s_waitcnt lgkmcnt(0)
    v_mfma_f32_16x16x32_bf16 v[20:23], v[44:47], v[72:75], 0
    v_smfmac_f32_16x16x32_bf16 v[88:91], v[42:43], v[36:39], v16
    v_exp_f32 v32, v24
    v_exp_f32 v33, v25
    v_exp_f32 v34, v26
    v_exp_f32 v35, v27
    v_pk_add_f32 v[32:33], v[32:33], 1.0 op_sel_hi:[1,0]
    v_pk_add_f32 v[34:35], v[34:35], 1.0 op_sel_hi:[1,0]
    v_rcp_f32 v32, v32
    v_rcp_f32 v33, v33
    v_rcp_f32 v34, v34
    v_rcp_f32 v35, v35
    v_pk_mul_f32 v[24:25], v[32:33], v[24:25]
    v_pk_mul_f32 v[26:27], v[34:35], v[26:27]
    v_mul_f32 v28, 0x72000000, v28
    v_mul_f32 v29, 0x72000000, v29
    v_mul_f32 v30, 0x72000000, v30
    v_mul_f32 v31, 0x72000000, v31
    v_exp_f32 v32, v28
    v_exp_f32 v33, v29
    v_exp_f32 v34, v30
    v_exp_f32 v35, v31
    v_pk_add_f32 v[32:33], v[32:33], 1.0 op_sel_hi:[1,0]
    v_pk_add_f32 v[34:35], v[34:35], 1.0 op_sel_hi:[1,0]
    v_rcp_f32 v32, v32
    v_rcp_f32 v33, v33
    v_rcp_f32 v34, v34
    v_rcp_f32 v35, v35
    v_pk_mul_f32 v[36:37], v[32:33], v[28:29]
    v_pk_mul_f32 v[38:39], v[34:35], v[30:31]
    v_mad_u32_u16 v13, v14, s64, v7 op_sel:[1,0,0,0]
    s_mov_b32 m0, s72
    s_waitcnt vmcnt(2)
    ds_read_b128 v[52:55], v1 offset:3072
    ds_read_b64 v[44:45], v12
    ds_read_b32 v14, v10
    buffer_load_dwordx4 v5, s[24:27], s65 offen lds
    v_mfma_f32_16x16x32_bf16 v[28:31], v[48:51], v[74:77], 0
    v_smfmac_f32_16x16x32_bf16 v[92:95], v[42:43], v[24:27], v16
    s_waitcnt lgkmcnt(2)
    v_mfma_f32_16x16x32_bf16 v[24:27], v[50:53], v[78:81], 0
    v_smfmac_f32_16x16x32_bf16 v[96:99], v[42:43], v[36:39], v16
    v_exp_f32 v32, v20
    v_exp_f32 v33, v21
    v_exp_f32 v34, v22
    v_exp_f32 v35, v23
    v_pk_add_f32 v[32:33], v[32:33], 1.0 op_sel_hi:[1,0]
    v_pk_add_f32 v[34:35], v[34:35], 1.0 op_sel_hi:[1,0]
    v_rcp_f32 v32, v32
    v_rcp_f32 v33, v33
    v_rcp_f32 v34, v34
    v_rcp_f32 v35, v35
    v_pk_mul_f32 v[20:21], v[32:33], v[20:21]
    v_pk_mul_f32 v[22:23], v[34:35], v[22:23]
    v_mul_f32 v28, 0x72000000, v28
    v_mul_f32 v29, 0x72000000, v29
    v_mul_f32 v30, 0x72000000, v30
    v_mul_f32 v31, 0x72000000, v31
    v_exp_f32 v32, v28
    v_exp_f32 v33, v29
    v_exp_f32 v34, v30
    v_exp_f32 v35, v31
    v_pk_add_f32 v[32:33], v[32:33], 1.0 op_sel_hi:[1,0]
    v_pk_add_f32 v[34:35], v[34:35], 1.0 op_sel_hi:[1,0]
    v_rcp_f32 v32, v32
    v_rcp_f32 v33, v33
    v_rcp_f32 v34, v34
    v_rcp_f32 v35, v35
    v_pk_mul_f32 v[36:37], v[32:33], v[28:29]
    v_pk_mul_f32 v[38:39], v[34:35], v[30:31]
    v_lshl_add_u64 v[10:11], v[10:11], 0, s[66:67]
    v_lshl_add_u64 v[6:7], v[6:7], 0, v[8:9]
    s_add_u32 s53, s53, 16
    s_mov_b32 m0, s73
    s_waitcnt vmcnt(2)
    ds_read_b128 v[46:49], v1 offset:0
    ds_read_b64 v[50:51], v12
    buffer_load_dwordx4 v5, s[24:27], s68 offen lds
    v_mfma_f32_16x16x32_bf16 v[28:31], v[54:57], v[80:83], 0
    v_smfmac_f32_16x16x32_bf16 v[100:103], v[42:43], v[20:23], v16
    s_waitcnt lgkmcnt(1)
    v_mfma_f32_16x16x32_bf16 v[20:23], v[44:47], v[60:63], 0
    v_smfmac_f32_16x16x32_bf16 v[104:107], v[42:43], v[36:39], v16
    v_exp_f32 v32, v24
    v_exp_f32 v33, v25
    v_exp_f32 v34, v26
    v_exp_f32 v35, v27
    v_pk_add_f32 v[32:33], v[32:33], 1.0 op_sel_hi:[1,0]
    v_pk_add_f32 v[34:35], v[34:35], 1.0 op_sel_hi:[1,0]
    v_rcp_f32 v32, v32
    v_rcp_f32 v33, v33
    v_rcp_f32 v34, v34
    v_rcp_f32 v35, v35
    v_pk_mul_f32 v[24:25], v[32:33], v[24:25]
    v_pk_mul_f32 v[26:27], v[34:35], v[26:27]
    v_mul_f32 v28, 0x72000000, v28
    v_mul_f32 v29, 0x72000000, v29
    v_mul_f32 v30, 0x72000000, v30
    v_mul_f32 v31, 0x72000000, v31
    v_exp_f32 v32, v28
    v_exp_f32 v33, v29
    v_exp_f32 v34, v30
    v_exp_f32 v35, v31
    v_pk_add_f32 v[32:33], v[32:33], 1.0 op_sel_hi:[1,0]
    v_pk_add_f32 v[34:35], v[34:35], 1.0 op_sel_hi:[1,0]
    v_rcp_f32 v32, v32
    v_rcp_f32 v33, v33
    v_rcp_f32 v34, v34
    v_rcp_f32 v35, v35
    v_pk_mul_f32 v[36:37], v[32:33], v[28:29]
    v_pk_mul_f32 v[38:39], v[34:35], v[30:31]
    v_mad_u32_u16 v5, v14, s66, v2
    s_cmp_lt_i32 s53, s59
    s_mov_b32 m0, s70
    s_waitcnt vmcnt(2)
    ds_read_b128 v[52:55], v1 offset:1024
    ds_read_b64 v[56:57], v12
    ds_read_b32 v15, v11
    buffer_load_dwordx4 v5, s[24:27], 0 offen lds
    s_cbranch_scc1 K_LOOPF
    s_branch K_EV
K_OVF:
    v_lshrrev_b32 v49, 3, v18
    v_subrev_u32 v49, s44, v49
    v_and_b32 v49, 127, v49
    v_lshlrev_b32 v55, v49, v19
    v_lshrrev_b32 v49, 5, v49
    v_lshlrev_b32 v49, 2, v49
    s_mov_b64 exec, vcc
    ds_or_b32 v49, v55 offset:208
    s_mov_b64 exec, -1
    s_branch K_OVFB
K_MASK:
    v_readlane_b32 s40, v49, 52
    v_readlane_b32 s41, v49, 53
    v_readlane_b32 s42, v49, 54
    v_readlane_b32 s43, v49, 55
    v_cmp_gt_u32 vcc, 52, v0
    s_mov_b32 s47, 1
    s_nop 0
    v_cndmask_b32 v49, 0, v49, vcc
    s_branch K_MASKB
K_SHRINK:
    s_movk_i32 s51, 504
    s_mov_b32 s50, 0
    s_mov_b32 s47, 1
    s_branch K_ROUND
K_NEXT:
    s_mov_b32 s69, 0
    s_add_u32 s50, s50, s51
    s_cmp_lt_u32 s51, 1024
    s_cselect_b32 s76, s50, 1024
    s_cmp_lt_u32 s76, 1024
    s_cbranch_scc1 K_ROUND
    s_mov_b32 s50, 0
    s_movk_i32 s51, 1024
    s_ff1_i32_b64 s49, s[40:41]
    s_cmp_lt_i32 s49, 0
    s_cbranch_scc1 K_NEXT2
    s_bitset0_b64 s[40:41], s49
    s_branch K_ROUND
K_NEXT2:
    s_ff1_i32_b64 s49, s[42:43]
    s_cmp_lt_i32 s49, 0
    s_cbranch_scc0 K_NEXT3
    s_cmp_lg_u32 s79, 0
    s_cbranch_scc1 K_S1
    s_branch K_S0
K_NEXT3:
    s_bitset0_b64 s[42:43], s49
    s_add_u32 s49, s49, 64
K_ROUND:
    s_load_dwordx2 s[6:7], s[0:1], 8
    s_load_dwordx4 s[8:11], s[0:1], 16
    s_load_dwordx2 s[12:13], s[0:1], 32
    s_lshl_b32 s76, s3, 6
    v_add_u32 v18, s76, v0
    v_lshlrev_b32 v19, 4, v18
    s_waitcnt vmcnt(0) lgkmcnt(0)
    s_barrier
    v_mov_b32 v24, 0
    v_mov_b32 v25, 0
    v_mov_b32 v26, 0
    v_mov_b32 v27, 0
    v_cmp_gt_u32 vcc, 226, v18
    ds_write_b128 v19, v[24:27] offset:8448
    v_lshlrev_b32 v28, 2, v0
    ds_write_b32 v28, v24 offset:0
    s_mov_b64 exec, vcc
    ds_write_b128 v19, v[24:27] offset:24832
    s_mov_b64 exec, -1
    s_mov_b32 s32, s6
    s_mov_b32 s33, s7
    s_mov_b32 s34, 75000
    s_mov_b32 s35, 0x20000
    s_cmp_ge_u32 s3, 10
    v_lshlrev_b32 v58, 4, v0
    s_cbranch_scc1 K_PR_E
    s_lshl_b32 s76, s3, 13
    s_add_u32 m0, s76, 73984
    s_cmp_eq_u32 s3, 9
    buffer_load_dwordx4 v58, s[32:35], s76 offen lds
    s_cselect_b64 exec, 0xffff, -1
    buffer_load_dwordx4 v58, s[32:35], s76 offen offset:1024 lds
    s_mov_b64 exec, -1
    s_cbranch_scc1 K_PR_E
    buffer_load_dwordx4 v58, s[32:35], s76 offen offset:2048 lds
    buffer_load_dwordx4 v58, s[32:35], s76 offen offset:3072 lds
    s_add_u32 m0, m0, 4096
    s_add_u32 s76, s76, 4096
    buffer_load_dwordx4 v58, s[32:35], s76 offen offset:0 lds
    buffer_load_dwordx4 v58, s[32:35], s76 offen offset:1024 lds
    buffer_load_dwordx4 v58, s[32:35], s76 offen offset:2048 lds
    buffer_load_dwordx4 v58, s[32:35], s76 offen offset:3072 lds
K_PR_E:
    s_mul_i32 s77, s44, 8320
    s_add_u32 s77, s77, 4210560
    s_add_u32 s84, s24, s77
    s_addc_u32 s85, s25, 0
    s_lshl_b32 s77, s44, 3
    v_and_b32 v31, -8, v18
    v_lshlrev_b32 v30, 2, v18
    v_mad_u32_u24 v30, v31, 12, v30
    v_subrev_u32 v28, s77, v18
    v_and_b32 v28, 1023, v28
    v_cmp_gt_u32 vcc, 1000, v28
    v_mov_b32 v28, v19
    v_mov_b32 v29, 0
    v_mov_b32 v17, 0xbfbfbfbf
    s_mov_b32 exec_lo, 0x3f3f3f3f
    s_mov_b32 exec_hi, 0x3f3f3f3f
    v_lshl_add_u64 v[28:29], v[28:29], 0, s[36:37]
    s_not_b64 exec, exec
    v_mad_i32_i24 v28, v31, -12, v19
    v_lshl_add_u64 v[28:29], v[28:29], 0, s[84:85]
    s_mov_b64 exec, -1
    s_cmp_ge_i32 s49, 0
    s_cbranch_scc1 K_RAW
    s_mov_b64 exec, vcc
    global_load_dword v17, v30, s[36:37] sc1
    global_load_dwordx4 v[20:23], v[28:29], off offset:32 sc1
    s_mov_b64 exec, -1
    s_waitcnt vmcnt(0)
    v_and_b32 v17, 0xbfbfbfbf, v17
    s_branch K_RANGE
K_RAW:
    s_cmp_ge_u32 s3, 13
    s_cbranch_scc1 K_RANGE
    s_mul_i32 s76, s49, 12800
    v_cmp_gt_u32 vcc, 800, v18
    v_add_u32 v28, s76, v19
    v_lshrrev_b32 v29, 1, v28
    s_mov_b64 exec, vcc
    global_load_dwordx4 v[32:35], v28, s[12:13]
    global_load_dwordx4 v[20:23], v28, s[10:11]
    global_load_dwordx2 v[36:37], v29, s[8:9]
    s_mov_b32 s76, 342393
    s_mov_b32 s77, 0xffff0000
    v_mov_b32 v38, 0xbf
    s_waitcnt vmcnt(0)
    v_mul_u32_u24 v32, s76, v32
    v_lshrrev_b32 v39, 24, v32
    v_cmp_eq_u32 vcc, s44, v39
    v_mul_hi_u32_u24 v32, 12544, v32
    v_lshl_or_b32 v20, v36, 16, v20
    v_cndmask_b32 v32, v38, v32, vcc
    v_mul_u32_u24 v33, s76, v33
    v_lshrrev_b32 v39, 24, v33
    v_cmp_eq_u32 vcc, s44, v39
    v_mul_hi_u32_u24 v33, 12544, v33
    v_and_or_b32 v21, v36, s77, v21
    v_cndmask_b32 v33, v38, v33, vcc
    v_mul_u32_u24 v34, s76, v34
    v_lshrrev_b32 v39, 24, v34
    v_cmp_eq_u32 vcc, s44, v39
    v_mul_hi_u32_u24 v34, 12544, v34
    v_lshl_or_b32 v22, v37, 16, v22
    v_cndmask_b32 v34, v38, v34, vcc
    v_mul_u32_u24 v35, s76, v35
    v_lshrrev_b32 v39, 24, v35
    v_cmp_eq_u32 vcc, s44, v39
    v_mul_hi_u32_u24 v35, 12544, v35
    v_and_or_b32 v23, v37, s77, v23
    v_cndmask_b32 v35, v38, v35, vcc
    v_lshl_or_b32 v32, v33, 8, v32
    v_lshl_or_b32 v34, v35, 8, v34
    v_lshl_or_b32 v17, v34, 16, v32
    s_mov_b64 exec, -1
K_RANGE:
    v_subrev_u32 v28, s50, v18
    v_cmp_gt_u32 vcc, s51, v28
    v_mov_b32 v28, 0xbfbfbfbf
    s_waitcnt vmcnt(0) lgkmcnt(0)
    v_cndmask_b32 v17, v28, v17, vcc
    s_barrier
    v_mov_b32 v38, 0
    s_branch K_B0
.section .rodata,"a"
.p2align 6
.amdhsa_kernel standalone__cheap_equivariant_egnn__graph_kernel
  .amdhsa_next_free_vgpr 128
  .amdhsa_next_free_sgpr 102
  .amdhsa_accum_offset 128
  .amdhsa_group_segment_fixed_size 0
  .amdhsa_kernarg_size 88
  .amdhsa_user_sgpr_count 2
  .amdhsa_user_sgpr_kernarg_segment_ptr 1
  .amdhsa_system_sgpr_workgroup_id_x 1
.end_amdhsa_kernel
```
